```python
import torch

def _softmax(x, axis=-1):
    return torch.softmax(x, dim=axis)
def _gelu(x):
    return torch.nn.functional.gelu(x, approximate="tanh")
def _silu(x):
    return torch.nn.functional.silu(x)
def _sigmoid(x):
    return torch.sigmoid(x)
def _layernorm(x, axis=-1, eps=1e-5):
    m = x.mean(dim=axis, keepdim=True)
    v = x.var(dim=axis, keepdim=True, unbiased=False)
    return (x - m) / torch.sqrt(v + eps)
def _scatter_add(tgt, idx, src, axis=0):
    return tgt.clone().index_add_(axis, idx, src)
def _segment_sum(src, seg, n):
    out = torch.zeros((n,) + src.shape[1:], dtype=src.dtype)
    return out.index_add_(0, seg, src)
def _pad(x, pw):
    flat = tuple(v for pair in reversed(pw) for v in pair)
    return torch.nn.functional.pad(x, flat)

kernel_name = 'gated_mix__ssm_conv_h3__sliding_block__prompt'

def setup_inputs():

    _w = (lambda a: (lambda t: t.to(torch.bfloat16) if t.is_floating_point() else t)(torch.as_tensor(a)))
    def _A_setup():
        B, S, D = 1, 2048, 512
        ks = 4
        return {
            "q": _w((lambda *s: torch.randn(*s, dtype=torch.bfloat16) * 0.05)(B, S, D)),
            "k": _w((lambda *s: torch.randn(*s, dtype=torch.bfloat16) * 0.8)(B, S, D)),
            "v": _w((lambda *s: torch.randn(*s, dtype=torch.bfloat16) * 0.8)(B, S, D)),
            "shift_k": _w((lambda *s: torch.randn(*s, dtype=torch.bfloat16) * 0.8)(D, ks) * 0.5),
            "ssm_k": _w((lambda *s: torch.randn(*s, dtype=torch.bfloat16) * 1.6)(D, S) * (1.0 / S ** 0.5)),
            "ssm_D": _w((lambda *s: torch.randn(*s, dtype=torch.bfloat16) * 0.8)(D)),
        }
    _A_in = _A_setup()

    def _B_setup():
        B, S, D = 1, 2048, 512
        return {
            "x": _w((lambda *s: torch.randn(*s, dtype=torch.bfloat16) * 0.05)(B, S, D)),
            "wqkv": _w((lambda *s: torch.randn(*s, dtype=torch.bfloat16) * 0.8)(D, 3 * D)),
            "wo": _w((lambda *s: torch.randn(*s, dtype=torch.bfloat16) * 0.05)(D, D)),
        }
    _B_in = _B_setup()

    return {
        "A_q": _A_in["q"],
        "A_k": _A_in["k"],
        "A_v": _A_in["v"],
        "A_shift_k": _A_in["shift_k"],
        "A_ssm_k": _A_in["ssm_k"],
        "A_ssm_D": _A_in["ssm_D"],
        "B_x": _B_in["x"],
        "B_wqkv": _B_in["wqkv"],
        "B_wo": _B_in["wo"],
        "gate_w": _w((lambda *s: torch.randn(*s, dtype=torch.bfloat16) * 0.05)(512) * 16.0),
    }

def reference(A_q, A_k, A_v, A_shift_k, A_ssm_k, A_ssm_D, B_x, B_wqkv, B_wo, gate_w):
    def _A_ref(q, k, v, shift_k, ssm_k, ssm_D):
        B, S, D = q.shape
        ks = shift_k.shape[-1]
        k_pad = _pad(k, ((0, 0), (ks - 1, 0), (0, 0)))
        k_shift = torch.zeros_like(k)
        for t in range(ks):
            k_shift = k_shift + k_pad[:, t:t + S, :] * shift_k[:, ks - 1 - t][None, None, :]
        kv = k_shift * v
        L = 2 * S
        kv_pad = _pad(kv, ((0, 0), (0, S), (0, 0)))
        kf_pad = _pad(ssm_k, ((0, 0), (0, S)))
        kv_f = (lambda x, axes=(-2,-1): torch.fft.rfft2(x.float(), dim=axes))(kv_pad[:, None, :, :], axes=(1, 2))
        kf_f = (lambda x, axes=(-2,-1): torch.fft.rfft2(x.float(), dim=axes))(kf_pad[:, None, :], axes=(1, 2))
        kf_f = (lambda x, *d: x.permute(*d))(kf_f, 1, 2, 0)
        y_f = kv_f * kf_f[None, :, :, :]
        y = (lambda x, s, axes=(-2,-1): torch.fft.irfft2(x, s=s, dim=axes).to(torch.bfloat16))(y_f, (1, L), axes=(1, 2))[:, 0, :S, :]
        y = y + kv * ssm_D[None, None, :]
        return q * y

    def _B_ref(x, wqkv, wo):
        B, S, D = x.shape
        H = 32; Dh = D // H; W = 256
        qkv = (lambda x, *d: x.permute(*d))((x @ wqkv).reshape(B, S, 3, H, Dh), 2, 0, 3, 1, 4)
        q, k, v = qkv[0], qkv[1], qkv[2]
        scores = torch.einsum("bhqd,bhkd->bhqk", q, k) * (Dh ** -0.5)
        idx = torch.arange(S)
        mask = (idx[:, None] - idx[None, :] >= 0) & (idx[:, None] - idx[None, :] < W)
        scores = torch.where(mask[None, None], scores, -1e9)
        p = _softmax(scores, axis=-1)
        o = torch.einsum("bhqk,bhkd->bhqd", p, v)
        return (lambda x, *d: x.permute(*d))(o, 0, 2, 1, 3).reshape(B, S, D) @ wo

    x = A_q
    g = _sigmoid((x * gate_w).sum(-1, keepdims=True))
    a = _A_ref(x, A_k, A_v, A_shift_k, A_ssm_k, A_ssm_D)
    b = _B_ref(x, B_wqkv, B_wo)
    return g * a + (1 - g) * b
```

```asm
; @launch kernel=k1_kernel grid=(896,1,1) block=(256,1,1) lds=53248
; @launch kernel=k2_kernel grid=(768,1,1) block=(256,1,1) lds=45696
; @launch kernel=k3_kernel grid=(256,1,1) block=(256,1,1) lds=133120
.amdgcn_target "amdgcn-amd-amdhsa--gfx950"
.text
.globl k1_kernel
.p2align 8
.type k1_kernel,@function
k1_kernel:
    s_cmp_ge_u32 s2, 896
    s_cbranch_scc1 K1_END
    s_load_dwordx4 s[4:7], s[0:1], 0
    s_load_dwordx4 s[8:11], s[0:1], 16
    s_load_dwordx4 s[16:19], s[0:1], 56
    s_load_dwordx2 s[20:21], s[0:1], 96
    s_load_dwordx2 s[22:23], s[0:1], 72
    v_and_b32 v1, 63, v0
    v_lshrrev_b32 v2, 6, v0
    s_waitcnt lgkmcnt(0)
    s_mov_b32 s24, s20
    s_and_b32 s25, s21, 0xffff
    s_mov_b32 s26, 268435456
    s_mov_b32 s27, 0x00020000
    s_cmp_lt_u32 s2, 384
    s_cbranch_scc1 K1_GEMM
    s_cmp_lt_u32 s2, 640
    s_cbranch_scc1 K1_KV
    s_cmp_lt_u32 s2, 768
    s_cbranch_scc1 K1_WOT
    s_mov_b32 s28, s4
    s_and_b32 s29, s5, 0xffff
    s_mov_b32 s30, 2097152
    s_mov_b32 s31, 0x00020000
    s_mov_b32 s32, s22
    s_and_b32 s33, s23, 0xffff
    s_mov_b32 s34, 1024
    s_mov_b32 s35, 0x00020000
    s_sub_u32 s3, s2, 768
    s_lshl_b32 s3, s3, 4
    v_lshrrev_b32 v6, 4, v0
    v_add_u32 v6, s3, v6
    v_and_b32 v7, 15, v0
    v_lshlrev_b32 v8, 10, v6
    v_lshl_add_u32 v8, v7, 4, v8
    v_lshlrev_b32 v9, 4, v7
    buffer_load_dwordx4 v[80:83], v8, s[28:31], 0 offen offset:0
    buffer_load_dwordx4 v[96:99], v9, s[32:35], 0 offen offset:0
    buffer_load_dwordx4 v[84:87], v8, s[28:31], 0 offen offset:256
    buffer_load_dwordx4 v[100:103], v9, s[32:35], 0 offen offset:256
    buffer_load_dwordx4 v[88:91], v8, s[28:31], 0 offen offset:512
    buffer_load_dwordx4 v[104:107], v9, s[32:35], 0 offen offset:512
    buffer_load_dwordx4 v[92:95], v8, s[28:31], 0 offen offset:768
    buffer_load_dwordx4 v[108:111], v9, s[32:35], 0 offen offset:768
    s_waitcnt vmcnt(0)
    v_mov_b32 v11, 0
    v_lshlrev_b32 v12, 16, v80
    v_lshlrev_b32 v13, 16, v96
    v_mul_f32 v12, v12, v13
    v_cvt_pk_bf16_f32 v12, v12, v12
    v_lshlrev_b32 v12, 16, v12
    v_add_f32 v11, v11, v12
    v_and_b32 v12, 0xffff0000, v80
    v_and_b32 v13, 0xffff0000, v96
    v_mul_f32 v12, v12, v13
    v_cvt_pk_bf16_f32 v12, v12, v12
    v_lshlrev_b32 v12, 16, v12
    v_add_f32 v11, v11, v12
    v_lshlrev_b32 v12, 16, v81
    v_lshlrev_b32 v13, 16, v97
    v_mul_f32 v12, v12, v13
    v_cvt_pk_bf16_f32 v12, v12, v12
    v_lshlrev_b32 v12, 16, v12
    v_add_f32 v11, v11, v12
    v_and_b32 v12, 0xffff0000, v81
    v_and_b32 v13, 0xffff0000, v97
    v_mul_f32 v12, v12, v13
    v_cvt_pk_bf16_f32 v12, v12, v12
    v_lshlrev_b32 v12, 16, v12
    v_add_f32 v11, v11, v12
    v_lshlrev_b32 v12, 16, v82
    v_lshlrev_b32 v13, 16, v98
    v_mul_f32 v12, v12, v13
    v_cvt_pk_bf16_f32 v12, v12, v12
    v_lshlrev_b32 v12, 16, v12
    v_add_f32 v11, v11, v12
    v_and_b32 v12, 0xffff0000, v82
    v_and_b32 v13, 0xffff0000, v98
    v_mul_f32 v12, v12, v13
    v_cvt_pk_bf16_f32 v12, v12, v12
    v_lshlrev_b32 v12, 16, v12
    v_add_f32 v11, v11, v12
    v_lshlrev_b32 v12, 16, v83
    v_lshlrev_b32 v13, 16, v99
    v_mul_f32 v12, v12, v13
    v_cvt_pk_bf16_f32 v12, v12, v12
    v_lshlrev_b32 v12, 16, v12
    v_add_f32 v11, v11, v12
    v_and_b32 v12, 0xffff0000, v83
    v_and_b32 v13, 0xffff0000, v99
    v_mul_f32 v12, v12, v13
    v_cvt_pk_bf16_f32 v12, v12, v12
    v_lshlrev_b32 v12, 16, v12
    v_add_f32 v11, v11, v12
    v_lshlrev_b32 v12, 16, v84
    v_lshlrev_b32 v13, 16, v100
    v_mul_f32 v12, v12, v13
    v_cvt_pk_bf16_f32 v12, v12, v12
    v_lshlrev_b32 v12, 16, v12
    v_add_f32 v11, v11, v12
    v_and_b32 v12, 0xffff0000, v84
    v_and_b32 v13, 0xffff0000, v100
    v_mul_f32 v12, v12, v13
    v_cvt_pk_bf16_f32 v12, v12, v12
    v_lshlrev_b32 v12, 16, v12
    v_add_f32 v11, v11, v12
    v_lshlrev_b32 v12, 16, v85
    v_lshlrev_b32 v13, 16, v101
    v_mul_f32 v12, v12, v13
    v_cvt_pk_bf16_f32 v12, v12, v12
    v_lshlrev_b32 v12, 16, v12
    v_add_f32 v11, v11, v12
    v_and_b32 v12, 0xffff0000, v85
    v_and_b32 v13, 0xffff0000, v101
    v_mul_f32 v12, v12, v13
    v_cvt_pk_bf16_f32 v12, v12, v12
    v_lshlrev_b32 v12, 16, v12
    v_add_f32 v11, v11, v12
    v_lshlrev_b32 v12, 16, v86
    v_lshlrev_b32 v13, 16, v102
    v_mul_f32 v12, v12, v13
    v_cvt_pk_bf16_f32 v12, v12, v12
    v_lshlrev_b32 v12, 16, v12
    v_add_f32 v11, v11, v12
    v_and_b32 v12, 0xffff0000, v86
    v_and_b32 v13, 0xffff0000, v102
    v_mul_f32 v12, v12, v13
    v_cvt_pk_bf16_f32 v12, v12, v12
    v_lshlrev_b32 v12, 16, v12
    v_add_f32 v11, v11, v12
    v_lshlrev_b32 v12, 16, v87
    v_lshlrev_b32 v13, 16, v103
    v_mul_f32 v12, v12, v13
    v_cvt_pk_bf16_f32 v12, v12, v12
    v_lshlrev_b32 v12, 16, v12
    v_add_f32 v11, v11, v12
    v_and_b32 v12, 0xffff0000, v87
    v_and_b32 v13, 0xffff0000, v103
    v_mul_f32 v12, v12, v13
    v_cvt_pk_bf16_f32 v12, v12, v12
    v_lshlrev_b32 v12, 16, v12
    v_add_f32 v11, v11, v12
    v_lshlrev_b32 v12, 16, v88
    v_lshlrev_b32 v13, 16, v104
    v_mul_f32 v12, v12, v13
    v_cvt_pk_bf16_f32 v12, v12, v12
    v_lshlrev_b32 v12, 16, v12
    v_add_f32 v11, v11, v12
    v_and_b32 v12, 0xffff0000, v88
    v_and_b32 v13, 0xffff0000, v104
    v_mul_f32 v12, v12, v13
    v_cvt_pk_bf16_f32 v12, v12, v12
    v_lshlrev_b32 v12, 16, v12
    v_add_f32 v11, v11, v12
    v_lshlrev_b32 v12, 16, v89
    v_lshlrev_b32 v13, 16, v105
    v_mul_f32 v12, v12, v13
    v_cvt_pk_bf16_f32 v12, v12, v12
    v_lshlrev_b32 v12, 16, v12
    v_add_f32 v11, v11, v12
    v_and_b32 v12, 0xffff0000, v89
    v_and_b32 v13, 0xffff0000, v105
    v_mul_f32 v12, v12, v13
    v_cvt_pk_bf16_f32 v12, v12, v12
    v_lshlrev_b32 v12, 16, v12
    v_add_f32 v11, v11, v12
    v_lshlrev_b32 v12, 16, v90
    v_lshlrev_b32 v13, 16, v106
    v_mul_f32 v12, v12, v13
    v_cvt_pk_bf16_f32 v12, v12, v12
    v_lshlrev_b32 v12, 16, v12
    v_add_f32 v11, v11, v12
    v_and_b32 v12, 0xffff0000, v90
    v_and_b32 v13, 0xffff0000, v106
    v_mul_f32 v12, v12, v13
    v_cvt_pk_bf16_f32 v12, v12, v12
    v_lshlrev_b32 v12, 16, v12
    v_add_f32 v11, v11, v12
    v_lshlrev_b32 v12, 16, v91
    v_lshlrev_b32 v13, 16, v107
    v_mul_f32 v12, v12, v13
    v_cvt_pk_bf16_f32 v12, v12, v12
    v_lshlrev_b32 v12, 16, v12
    v_add_f32 v11, v11, v12
    v_and_b32 v12, 0xffff0000, v91
    v_and_b32 v13, 0xffff0000, v107
    v_mul_f32 v12, v12, v13
    v_cvt_pk_bf16_f32 v12, v12, v12
    v_lshlrev_b32 v12, 16, v12
    v_add_f32 v11, v11, v12
    v_lshlrev_b32 v12, 16, v92
    v_lshlrev_b32 v13, 16, v108
    v_mul_f32 v12, v12, v13
    v_cvt_pk_bf16_f32 v12, v12, v12
    v_lshlrev_b32 v12, 16, v12
    v_add_f32 v11, v11, v12
    v_and_b32 v12, 0xffff0000, v92
    v_and_b32 v13, 0xffff0000, v108
    v_mul_f32 v12, v12, v13
    v_cvt_pk_bf16_f32 v12, v12, v12
    v_lshlrev_b32 v12, 16, v12
    v_add_f32 v11, v11, v12
    v_lshlrev_b32 v12, 16, v93
    v_lshlrev_b32 v13, 16, v109
    v_mul_f32 v12, v12, v13
    v_cvt_pk_bf16_f32 v12, v12, v12
    v_lshlrev_b32 v12, 16, v12
    v_add_f32 v11, v11, v12
    v_and_b32 v12, 0xffff0000, v93
    v_and_b32 v13, 0xffff0000, v109
    v_mul_f32 v12, v12, v13
    v_cvt_pk_bf16_f32 v12, v12, v12
    v_lshlrev_b32 v12, 16, v12
    v_add_f32 v11, v11, v12
    v_lshlrev_b32 v12, 16, v94
    v_lshlrev_b32 v13, 16, v110
    v_mul_f32 v12, v12, v13
    v_cvt_pk_bf16_f32 v12, v12, v12
    v_lshlrev_b32 v12, 16, v12
    v_add_f32 v11, v11, v12
    v_and_b32 v12, 0xffff0000, v94
    v_and_b32 v13, 0xffff0000, v110
    v_mul_f32 v12, v12, v13
    v_cvt_pk_bf16_f32 v12, v12, v12
    v_lshlrev_b32 v12, 16, v12
    v_add_f32 v11, v11, v12
    v_lshlrev_b32 v12, 16, v95
    v_lshlrev_b32 v13, 16, v111
    v_mul_f32 v12, v12, v13
    v_cvt_pk_bf16_f32 v12, v12, v12
    v_lshlrev_b32 v12, 16, v12
    v_add_f32 v11, v11, v12
    v_and_b32 v12, 0xffff0000, v95
    v_and_b32 v13, 0xffff0000, v111
    v_mul_f32 v12, v12, v13
    v_cvt_pk_bf16_f32 v12, v12, v12
    v_lshlrev_b32 v12, 16, v12
    v_add_f32 v11, v11, v12
    ds_swizzle_b32 v12, v11 offset:1055
    s_waitcnt lgkmcnt(0)
    v_add_f32 v11, v11, v12
    ds_swizzle_b32 v12, v11 offset:2079
    s_waitcnt lgkmcnt(0)
    v_add_f32 v11, v11, v12
    ds_swizzle_b32 v12, v11 offset:4127
    s_waitcnt lgkmcnt(0)
    v_add_f32 v11, v11, v12
    ds_swizzle_b32 v12, v11 offset:8223
    s_waitcnt lgkmcnt(0)
    v_add_f32 v11, v11, v12
    v_cvt_pk_bf16_f32 v11, v11, v11
    v_lshlrev_b32 v11, 16, v11
    v_mul_f32 v11, 0xbfb8aa3b, v11
    v_exp_f32 v11, v11
    s_nop 0
    v_add_f32 v11, 1.0, v11
    v_rcp_f32 v11, v11
    s_nop 0
    v_cvt_pk_bf16_f32 v11, v11, v11
    v_lshlrev_b32 v11, 16, v11
    v_lshlrev_b32 v12, 2, v6
    v_add_u32 v12, 11534336, v12
    buffer_store_dword v11, v12, s[24:27], 0 offen
    s_endpgm
K1_WOT:
    s_mov_b32 s28, s18
    s_and_b32 s29, s19, 0xffff
    s_mov_b32 s30, 524288
    s_mov_b32 s31, 0x00020000
    s_sub_u32 s3, s2, 640
    s_lshl_b32 s3, s3, 8
    v_add_u32 v3, s3, v0
    v_and_b32 v4, 511, v3
    v_lshrrev_b32 v5, 9, v3
    v_lshlrev_b32 v6, 13, v5
    v_lshl_add_u32 v6, v4, 1, v6
    s_mov_b32 s70, 0
    buffer_load_ushort v8, v6, s[28:31], s70 offen
    s_mov_b32 s70, 1024
    buffer_load_ushort v9, v6, s[28:31], s70 offen
    s_mov_b32 s70, 2048
    buffer_load_ushort v10, v6, s[28:31], s70 offen
    s_mov_b32 s70, 3072
    buffer_load_ushort v11, v6, s[28:31], s70 offen
    s_mov_b32 s70, 4096
    buffer_load_ushort v12, v6, s[28:31], s70 offen
    s_mov_b32 s70, 5120
    buffer_load_ushort v13, v6, s[28:31], s70 offen
    s_mov_b32 s70, 6144
    buffer_load_ushort v14, v6, s[28:31], s70 offen
    s_mov_b32 s70, 7168
    buffer_load_ushort v15, v6, s[28:31], s70 offen
    s_waitcnt vmcnt(0)
    v_lshlrev_b32 v9, 16, v9
    v_or_b32 v16, v8, v9
    v_lshlrev_b32 v11, 16, v11
    v_or_b32 v17, v10, v11
    v_lshlrev_b32 v13, 16, v13
    v_or_b32 v18, v12, v13
    v_lshlrev_b32 v15, 16, v15
    v_or_b32 v19, v14, v15
    v_lshlrev_b32 v6, 10, v4
    v_lshl_add_u32 v6, v5, 4, v6
    v_add_u32 v6, 8388608, v6
    buffer_store_dwordx4 v[16:19], v6, s[24:27], 0 offen
    s_endpgm
K1_KV:
    s_mov_b32 s28, s6
    s_and_b32 s29, s7, 0xffff
    s_mov_b32 s30, 2097152
    s_mov_b32 s31, 0x00020000
    s_mov_b32 s32, s8
    s_and_b32 s33, s9, 0xffff
    s_mov_b32 s34, 2097152
    s_mov_b32 s35, 0x00020000
    s_mov_b32 s36, s10
    s_and_b32 s37, s11, 0xffff
    s_mov_b32 s38, 4096
    s_mov_b32 s39, 0x00020000
    s_sub_u32 s3, s2, 384
    s_lshr_b32 s40, s3, 3
    s_lshl_b32 s40, s40, 6
    s_and_b32 s41, s3, 7
    s_lshl_b32 s41, s41, 6
    v_and_b32 v3, 7, v0
    v_lshrrev_b32 v4, 3, v0
    v_add_u32 v5, s40, v4
    v_lshlrev_b32 v5, 10, v5
    v_lshl_add_u32 v5, v3, 4, v5
    s_lshl_b32 s42, s41, 1
    v_add_u32 v5, s42, v5
    v_add_u32 v6, -3072, v5
    buffer_load_dwordx4 v[16:19], v6, s[28:31], 0 offen
    v_add_u32 v6, -2048, v5
    buffer_load_dwordx4 v[20:23], v6, s[28:31], 0 offen
    v_add_u32 v6, -1024, v5
    buffer_load_dwordx4 v[24:27], v6, s[28:31], 0 offen
    v_add_u32 v6, 0, v5
    buffer_load_dwordx4 v[28:31], v6, s[28:31], 0 offen
    s_mov_b32 s70, 0
    buffer_load_dwordx4 v[48:51], v5, s[32:35], s70 offen
    v_add_u32 v6, 29696, v5
    buffer_load_dwordx4 v[32:35], v6, s[28:31], 0 offen
    v_add_u32 v6, 30720, v5
    buffer_load_dwordx4 v[36:39], v6, s[28:31], 0 offen
    v_add_u32 v6, 31744, v5
    buffer_load_dwordx4 v[40:43], v6, s[28:31], 0 offen
    v_add_u32 v6, 32768, v5
    buffer_load_dwordx4 v[44:47], v6, s[28:31], 0 offen
    s_mov_b32 s70, 32768
    buffer_load_dwordx4 v[52:55], v5, s[32:35], s70 offen
    v_add_u32 v6, s41, v3
    v_lshlrev_b32 v6, 3, v3
    v_add_u32 v6, s41, v6
    v_lshlrev_b32 v6, 3, v6
    buffer_load_dwordx4 v[56:59], v6, s[36:39], 0 offen offset:0
    buffer_load_dwordx4 v[60:63], v6, s[36:39], 0 offen offset:16
    buffer_load_dwordx4 v[64:67], v6, s[36:39], 0 offen offset:32
    buffer_load_dwordx4 v[68:71], v6, s[36:39], 0 offen offset:48
    s_waitcnt vmcnt(0)
    v_and_b32 v7, 7, v4
    v_sub_u32 v7, 7, v7
    v_and_b32 v8, 0x38, v4
    v_add_u32 v7, v7, v8
    v_lshlrev_b32 v7, 1, v7
    v_mul_u32_u24 v8, 1152, v3
    v_add_u32 v7, v7, v8
    v_lshlrev_b32 v80, 16, v56
    v_and_b32 v81, 0xffff0000, v56
    v_lshlrev_b32 v82, 16, v57
    v_and_b32 v83, 0xffff0000, v57
    v_lshlrev_b32 v84, 16, v16
    v_mul_f32 v84, v83, v84
    v_cvt_pk_bf16_f32 v84, v84, v84
    v_lshlrev_b32 v84, 16, v84
    v_lshlrev_b32 v85, 16, v20
    v_mul_f32 v85, v82, v85
    v_cvt_pk_bf16_f32 v85, v85, v85
    v_lshlrev_b32 v85, 16, v85
    v_add_f32 v84, v84, v85
    v_cvt_pk_bf16_f32 v84, v84, v84
    v_lshlrev_b32 v84, 16, v84
    v_lshlrev_b32 v85, 16, v24
    v_mul_f32 v85, v81, v85
    v_cvt_pk_bf16_f32 v85, v85, v85
    v_lshlrev_b32 v85, 16, v85
    v_add_f32 v84, v84, v85
    v_cvt_pk_bf16_f32 v84, v84, v84
    v_lshlrev_b32 v84, 16, v84
    v_lshlrev_b32 v85, 16, v28
    v_mul_f32 v85, v80, v85
    v_cvt_pk_bf16_f32 v85, v85, v85
    v_lshlrev_b32 v85, 16, v85
    v_add_f32 v84, v84, v85
    v_cvt_pk_bf16_f32 v84, v84, v84
    v_lshlrev_b32 v84, 16, v84
    v_lshlrev_b32 v85, 16, v48
    v_mul_f32 v84, v84, v85
    v_cvt_pk_bf16_f32 v84, v84, v84
    ds_write_b16 v7, v84 offset:0
    v_lshlrev_b32 v80, 16, v58
    v_and_b32 v81, 0xffff0000, v58
    v_lshlrev_b32 v82, 16, v59
    v_and_b32 v83, 0xffff0000, v59
    v_and_b32 v84, 0xffff0000, v16
    v_mul_f32 v84, v83, v84
    v_cvt_pk_bf16_f32 v84, v84, v84
    v_lshlrev_b32 v84, 16, v84
    v_and_b32 v85, 0xffff0000, v20
    v_mul_f32 v85, v82, v85
    v_cvt_pk_bf16_f32 v85, v85, v85
    v_lshlrev_b32 v85, 16, v85
    v_add_f32 v84, v84, v85
    v_cvt_pk_bf16_f32 v84, v84, v84
    v_lshlrev_b32 v84, 16, v84
    v_and_b32 v85, 0xffff0000, v24
    v_mul_f32 v85, v81, v85
    v_cvt_pk_bf16_f32 v85, v85, v85
    v_lshlrev_b32 v85, 16, v85
    v_add_f32 v84, v84, v85
    v_cvt_pk_bf16_f32 v84, v84, v84
    v_lshlrev_b32 v84, 16, v84
    v_and_b32 v85, 0xffff0000, v28
    v_mul_f32 v85, v80, v85
    v_cvt_pk_bf16_f32 v85, v85, v85
    v_lshlrev_b32 v85, 16, v85
    v_add_f32 v84, v84, v85
    v_cvt_pk_bf16_f32 v84, v84, v84
    v_lshlrev_b32 v84, 16, v84
    v_and_b32 v85, 0xffff0000, v48
    v_mul_f32 v84, v84, v85
    v_cvt_pk_bf16_f32 v84, v84, v84
    ds_write_b16 v7, v84 offset:144
    v_lshlrev_b32 v80, 16, v60
    v_and_b32 v81, 0xffff0000, v60
    v_lshlrev_b32 v82, 16, v61
    v_and_b32 v83, 0xffff0000, v61
    v_lshlrev_b32 v84, 16, v17
    v_mul_f32 v84, v83, v84
    v_cvt_pk_bf16_f32 v84, v84, v84
    v_lshlrev_b32 v84, 16, v84
    v_lshlrev_b32 v85, 16, v21
    v_mul_f32 v85, v82, v85
    v_cvt_pk_bf16_f32 v85, v85, v85
    v_lshlrev_b32 v85, 16, v85
    v_add_f32 v84, v84, v85
    v_cvt_pk_bf16_f32 v84, v84, v84
    v_lshlrev_b32 v84, 16, v84
    v_lshlrev_b32 v85, 16, v25
    v_mul_f32 v85, v81, v85
    v_cvt_pk_bf16_f32 v85, v85, v85
    v_lshlrev_b32 v85, 16, v85
    v_add_f32 v84, v84, v85
    v_cvt_pk_bf16_f32 v84, v84, v84
    v_lshlrev_b32 v84, 16, v84
    v_lshlrev_b32 v85, 16, v29
    v_mul_f32 v85, v80, v85
    v_cvt_pk_bf16_f32 v85, v85, v85
    v_lshlrev_b32 v85, 16, v85
    v_add_f32 v84, v84, v85
    v_cvt_pk_bf16_f32 v84, v84, v84
    v_lshlrev_b32 v84, 16, v84
    v_lshlrev_b32 v85, 16, v49
    v_mul_f32 v84, v84, v85
    v_cvt_pk_bf16_f32 v84, v84, v84
    ds_write_b16 v7, v84 offset:288
    v_lshlrev_b32 v80, 16, v62
    v_and_b32 v81, 0xffff0000, v62
    v_lshlrev_b32 v82, 16, v63
    v_and_b32 v83, 0xffff0000, v63
    v_and_b32 v84, 0xffff0000, v17
    v_mul_f32 v84, v83, v84
    v_cvt_pk_bf16_f32 v84, v84, v84
    v_lshlrev_b32 v84, 16, v84
    v_and_b32 v85, 0xffff0000, v21
    v_mul_f32 v85, v82, v85
    v_cvt_pk_bf16_f32 v85, v85, v85
    v_lshlrev_b32 v85, 16, v85
    v_add_f32 v84, v84, v85
    v_cvt_pk_bf16_f32 v84, v84, v84
    v_lshlrev_b32 v84, 16, v84
    v_and_b32 v85, 0xffff0000, v25
    v_mul_f32 v85, v81, v85
    v_cvt_pk_bf16_f32 v85, v85, v85
    v_lshlrev_b32 v85, 16, v85
    v_add_f32 v84, v84, v85
    v_cvt_pk_bf16_f32 v84, v84, v84
    v_lshlrev_b32 v84, 16, v84
    v_and_b32 v85, 0xffff0000, v29
    v_mul_f32 v85, v80, v85
    v_cvt_pk_bf16_f32 v85, v85, v85
    v_lshlrev_b32 v85, 16, v85
    v_add_f32 v84, v84, v85
    v_cvt_pk_bf16_f32 v84, v84, v84
    v_lshlrev_b32 v84, 16, v84
    v_and_b32 v85, 0xffff0000, v49
    v_mul_f32 v84, v84, v85
    v_cvt_pk_bf16_f32 v84, v84, v84
    ds_write_b16 v7, v84 offset:432
    v_lshlrev_b32 v80, 16, v64
    v_and_b32 v81, 0xffff0000, v64
    v_lshlrev_b32 v82, 16, v65
    v_and_b32 v83, 0xffff0000, v65
    v_lshlrev_b32 v84, 16, v18
    v_mul_f32 v84, v83, v84
    v_cvt_pk_bf16_f32 v84, v84, v84
    v_lshlrev_b32 v84, 16, v84
    v_lshlrev_b32 v85, 16, v22
    v_mul_f32 v85, v82, v85
    v_cvt_pk_bf16_f32 v85, v85, v85
    v_lshlrev_b32 v85, 16, v85
    v_add_f32 v84, v84, v85
    v_cvt_pk_bf16_f32 v84, v84, v84
    v_lshlrev_b32 v84, 16, v84
    v_lshlrev_b32 v85, 16, v26
    v_mul_f32 v85, v81, v85
    v_cvt_pk_bf16_f32 v85, v85, v85
    v_lshlrev_b32 v85, 16, v85
    v_add_f32 v84, v84, v85
    v_cvt_pk_bf16_f32 v84, v84, v84
    v_lshlrev_b32 v84, 16, v84
    v_lshlrev_b32 v85, 16, v30
    v_mul_f32 v85, v80, v85
    v_cvt_pk_bf16_f32 v85, v85, v85
    v_lshlrev_b32 v85, 16, v85
    v_add_f32 v84, v84, v85
    v_cvt_pk_bf16_f32 v84, v84, v84
    v_lshlrev_b32 v84, 16, v84
    v_lshlrev_b32 v85, 16, v50
    v_mul_f32 v84, v84, v85
    v_cvt_pk_bf16_f32 v84, v84, v84
    ds_write_b16 v7, v84 offset:576
    v_lshlrev_b32 v80, 16, v66
    v_and_b32 v81, 0xffff0000, v66
    v_lshlrev_b32 v82, 16, v67
    v_and_b32 v83, 0xffff0000, v67
    v_and_b32 v84, 0xffff0000, v18
    v_mul_f32 v84, v83, v84
    v_cvt_pk_bf16_f32 v84, v84, v84
    v_lshlrev_b32 v84, 16, v84
    v_and_b32 v85, 0xffff0000, v22
    v_mul_f32 v85, v82, v85
    v_cvt_pk_bf16_f32 v85, v85, v85
    v_lshlrev_b32 v85, 16, v85
    v_add_f32 v84, v84, v85
    v_cvt_pk_bf16_f32 v84, v84, v84
    v_lshlrev_b32 v84, 16, v84
    v_and_b32 v85, 0xffff0000, v26
    v_mul_f32 v85, v81, v85
    v_cvt_pk_bf16_f32 v85, v85, v85
    v_lshlrev_b32 v85, 16, v85
    v_add_f32 v84, v84, v85
    v_cvt_pk_bf16_f32 v84, v84, v84
    v_lshlrev_b32 v84, 16, v84
    v_and_b32 v85, 0xffff0000, v30
    v_mul_f32 v85, v80, v85
    v_cvt_pk_bf16_f32 v85, v85, v85
    v_lshlrev_b32 v85, 16, v85
    v_add_f32 v84, v84, v85
    v_cvt_pk_bf16_f32 v84, v84, v84
    v_lshlrev_b32 v84, 16, v84
    v_and_b32 v85, 0xffff0000, v50
    v_mul_f32 v84, v84, v85
    v_cvt_pk_bf16_f32 v84, v84, v84
    ds_write_b16 v7, v84 offset:720
    v_lshlrev_b32 v80, 16, v68
    v_and_b32 v81, 0xffff0000, v68
    v_lshlrev_b32 v82, 16, v69
    v_and_b32 v83, 0xffff0000, v69
    v_lshlrev_b32 v84, 16, v19
    v_mul_f32 v84, v83, v84
    v_cvt_pk_bf16_f32 v84, v84, v84
    v_lshlrev_b32 v84, 16, v84
    v_lshlrev_b32 v85, 16, v23
    v_mul_f32 v85, v82, v85
    v_cvt_pk_bf16_f32 v85, v85, v85
    v_lshlrev_b32 v85, 16, v85
    v_add_f32 v84, v84, v85
    v_cvt_pk_bf16_f32 v84, v84, v84
    v_lshlrev_b32 v84, 16, v84
    v_lshlrev_b32 v85, 16, v27
    v_mul_f32 v85, v81, v85
    v_cvt_pk_bf16_f32 v85, v85, v85
    v_lshlrev_b32 v85, 16, v85
    v_add_f32 v84, v84, v85
    v_cvt_pk_bf16_f32 v84, v84, v84
    v_lshlrev_b32 v84, 16, v84
    v_lshlrev_b32 v85, 16, v31
    v_mul_f32 v85, v80, v85
    v_cvt_pk_bf16_f32 v85, v85, v85
    v_lshlrev_b32 v85, 16, v85
    v_add_f32 v84, v84, v85
    v_cvt_pk_bf16_f32 v84, v84, v84
    v_lshlrev_b32 v84, 16, v84
    v_lshlrev_b32 v85, 16, v51
    v_mul_f32 v84, v84, v85
    v_cvt_pk_bf16_f32 v84, v84, v84
    ds_write_b16 v7, v84 offset:864
    v_lshlrev_b32 v80, 16, v70
    v_and_b32 v81, 0xffff0000, v70
    v_lshlrev_b32 v82, 16, v71
    v_and_b32 v83, 0xffff0000, v71
    v_and_b32 v84, 0xffff0000, v19
    v_mul_f32 v84, v83, v84
    v_cvt_pk_bf16_f32 v84, v84, v84
    v_lshlrev_b32 v84, 16, v84
    v_and_b32 v85, 0xffff0000, v23
    v_mul_f32 v85, v82, v85
    v_cvt_pk_bf16_f32 v85, v85, v85
    v_lshlrev_b32 v85, 16, v85
    v_add_f32 v84, v84, v85
    v_cvt_pk_bf16_f32 v84, v84, v84
    v_lshlrev_b32 v84, 16, v84
    v_and_b32 v85, 0xffff0000, v27
    v_mul_f32 v85, v81, v85
    v_cvt_pk_bf16_f32 v85, v85, v85
    v_lshlrev_b32 v85, 16, v85
    v_add_f32 v84, v84, v85
    v_cvt_pk_bf16_f32 v84, v84, v84
    v_lshlrev_b32 v84, 16, v84
    v_and_b32 v85, 0xffff0000, v31
    v_mul_f32 v85, v80, v85
    v_cvt_pk_bf16_f32 v85, v85, v85
    v_lshlrev_b32 v85, 16, v85
    v_add_f32 v84, v84, v85
    v_cvt_pk_bf16_f32 v84, v84, v84
    v_lshlrev_b32 v84, 16, v84
    v_and_b32 v85, 0xffff0000, v51
    v_mul_f32 v84, v84, v85
    v_cvt_pk_bf16_f32 v84, v84, v84
    ds_write_b16 v7, v84 offset:1008
    v_lshlrev_b32 v80, 16, v56
    v_and_b32 v81, 0xffff0000, v56
    v_lshlrev_b32 v82, 16, v57
    v_and_b32 v83, 0xffff0000, v57
    v_lshlrev_b32 v84, 16, v32
    v_mul_f32 v84, v83, v84
    v_cvt_pk_bf16_f32 v84, v84, v84
    v_lshlrev_b32 v84, 16, v84
    v_lshlrev_b32 v85, 16, v36
    v_mul_f32 v85, v82, v85
    v_cvt_pk_bf16_f32 v85, v85, v85
    v_lshlrev_b32 v85, 16, v85
    v_add_f32 v84, v84, v85
    v_cvt_pk_bf16_f32 v84, v84, v84
    v_lshlrev_b32 v84, 16, v84
    v_lshlrev_b32 v85, 16, v40
    v_mul_f32 v85, v81, v85
    v_cvt_pk_bf16_f32 v85, v85, v85
    v_lshlrev_b32 v85, 16, v85
    v_add_f32 v84, v84, v85
    v_cvt_pk_bf16_f32 v84, v84, v84
    v_lshlrev_b32 v84, 16, v84
    v_lshlrev_b32 v85, 16, v44
    v_mul_f32 v85, v80, v85
    v_cvt_pk_bf16_f32 v85, v85, v85
    v_lshlrev_b32 v85, 16, v85
    v_add_f32 v84, v84, v85
    v_cvt_pk_bf16_f32 v84, v84, v84
    v_lshlrev_b32 v84, 16, v84
    v_lshlrev_b32 v85, 16, v52
    v_mul_f32 v84, v84, v85
    v_cvt_pk_bf16_f32 v84, v84, v84
    ds_write_b16 v7, v84 offset:64
    v_lshlrev_b32 v80, 16, v58
    v_and_b32 v81, 0xffff0000, v58
    v_lshlrev_b32 v82, 16, v59
    v_and_b32 v83, 0xffff0000, v59
    v_and_b32 v84, 0xffff0000, v32
    v_mul_f32 v84, v83, v84
    v_cvt_pk_bf16_f32 v84, v84, v84
    v_lshlrev_b32 v84, 16, v84
    v_and_b32 v85, 0xffff0000, v36
    v_mul_f32 v85, v82, v85
    v_cvt_pk_bf16_f32 v85, v85, v85
    v_lshlrev_b32 v85, 16, v85
    v_add_f32 v84, v84, v85
    v_cvt_pk_bf16_f32 v84, v84, v84
    v_lshlrev_b32 v84, 16, v84
    v_and_b32 v85, 0xffff0000, v40
    v_mul_f32 v85, v81, v85
    v_cvt_pk_bf16_f32 v85, v85, v85
    v_lshlrev_b32 v85, 16, v85
    v_add_f32 v84, v84, v85
    v_cvt_pk_bf16_f32 v84, v84, v84
    v_lshlrev_b32 v84, 16, v84
    v_and_b32 v85, 0xffff0000, v44
    v_mul_f32 v85, v80, v85
    v_cvt_pk_bf16_f32 v85, v85, v85
    v_lshlrev_b32 v85, 16, v85
    v_add_f32 v84, v84, v85
    v_cvt_pk_bf16_f32 v84, v84, v84
    v_lshlrev_b32 v84, 16, v84
    v_and_b32 v85, 0xffff0000, v52
    v_mul_f32 v84, v84, v85
    v_cvt_pk_bf16_f32 v84, v84, v84
    ds_write_b16 v7, v84 offset:208
    v_lshlrev_b32 v80, 16, v60
    v_and_b32 v81, 0xffff0000, v60
    v_lshlrev_b32 v82, 16, v61
    v_and_b32 v83, 0xffff0000, v61
    v_lshlrev_b32 v84, 16, v33
    v_mul_f32 v84, v83, v84
    v_cvt_pk_bf16_f32 v84, v84, v84
    v_lshlrev_b32 v84, 16, v84
    v_lshlrev_b32 v85, 16, v37
    v_mul_f32 v85, v82, v85
    v_cvt_pk_bf16_f32 v85, v85, v85
    v_lshlrev_b32 v85, 16, v85
    v_add_f32 v84, v84, v85
    v_cvt_pk_bf16_f32 v84, v84, v84
    v_lshlrev_b32 v84, 16, v84
    v_lshlrev_b32 v85, 16, v41
    v_mul_f32 v85, v81, v85
    v_cvt_pk_bf16_f32 v85, v85, v85
    v_lshlrev_b32 v85, 16, v85
    v_add_f32 v84, v84, v85
    v_cvt_pk_bf16_f32 v84, v84, v84
    v_lshlrev_b32 v84, 16, v84
    v_lshlrev_b32 v85, 16, v45
    v_mul_f32 v85, v80, v85
    v_cvt_pk_bf16_f32 v85, v85, v85
    v_lshlrev_b32 v85, 16, v85
    v_add_f32 v84, v84, v85
    v_cvt_pk_bf16_f32 v84, v84, v84
    v_lshlrev_b32 v84, 16, v84
    v_lshlrev_b32 v85, 16, v53
    v_mul_f32 v84, v84, v85
    v_cvt_pk_bf16_f32 v84, v84, v84
    ds_write_b16 v7, v84 offset:352
    v_lshlrev_b32 v80, 16, v62
    v_and_b32 v81, 0xffff0000, v62
    v_lshlrev_b32 v82, 16, v63
    v_and_b32 v83, 0xffff0000, v63
    v_and_b32 v84, 0xffff0000, v33
    v_mul_f32 v84, v83, v84
    v_cvt_pk_bf16_f32 v84, v84, v84
    v_lshlrev_b32 v84, 16, v84
    v_and_b32 v85, 0xffff0000, v37
    v_mul_f32 v85, v82, v85
    v_cvt_pk_bf16_f32 v85, v85, v85
    v_lshlrev_b32 v85, 16, v85
    v_add_f32 v84, v84, v85
    v_cvt_pk_bf16_f32 v84, v84, v84
    v_lshlrev_b32 v84, 16, v84
    v_and_b32 v85, 0xffff0000, v41
    v_mul_f32 v85, v81, v85
    v_cvt_pk_bf16_f32 v85, v85, v85
    v_lshlrev_b32 v85, 16, v85
    v_add_f32 v84, v84, v85
    v_cvt_pk_bf16_f32 v84, v84, v84
    v_lshlrev_b32 v84, 16, v84
    v_and_b32 v85, 0xffff0000, v45
    v_mul_f32 v85, v80, v85
    v_cvt_pk_bf16_f32 v85, v85, v85
    v_lshlrev_b32 v85, 16, v85
    v_add_f32 v84, v84, v85
    v_cvt_pk_bf16_f32 v84, v84, v84
    v_lshlrev_b32 v84, 16, v84
    v_and_b32 v85, 0xffff0000, v53
    v_mul_f32 v84, v84, v85
    v_cvt_pk_bf16_f32 v84, v84, v84
    ds_write_b16 v7, v84 offset:496
    v_lshlrev_b32 v80, 16, v64
    v_and_b32 v81, 0xffff0000, v64
    v_lshlrev_b32 v82, 16, v65
    v_and_b32 v83, 0xffff0000, v65
    v_lshlrev_b32 v84, 16, v34
    v_mul_f32 v84, v83, v84
    v_cvt_pk_bf16_f32 v84, v84, v84
    v_lshlrev_b32 v84, 16, v84
    v_lshlrev_b32 v85, 16, v38
    v_mul_f32 v85, v82, v85
    v_cvt_pk_bf16_f32 v85, v85, v85
    v_lshlrev_b32 v85, 16, v85
    v_add_f32 v84, v84, v85
    v_cvt_pk_bf16_f32 v84, v84, v84
    v_lshlrev_b32 v84, 16, v84
    v_lshlrev_b32 v85, 16, v42
    v_mul_f32 v85, v81, v85
    v_cvt_pk_bf16_f32 v85, v85, v85
    v_lshlrev_b32 v85, 16, v85
    v_add_f32 v84, v84, v85
    v_cvt_pk_bf16_f32 v84, v84, v84
    v_lshlrev_b32 v84, 16, v84
    v_lshlrev_b32 v85, 16, v46
    v_mul_f32 v85, v80, v85
    v_cvt_pk_bf16_f32 v85, v85, v85
    v_lshlrev_b32 v85, 16, v85
    v_add_f32 v84, v84, v85
    v_cvt_pk_bf16_f32 v84, v84, v84
    v_lshlrev_b32 v84, 16, v84
    v_lshlrev_b32 v85, 16, v54
    v_mul_f32 v84, v84, v85
    v_cvt_pk_bf16_f32 v84, v84, v84
    ds_write_b16 v7, v84 offset:640
    v_lshlrev_b32 v80, 16, v66
    v_and_b32 v81, 0xffff0000, v66
    v_lshlrev_b32 v82, 16, v67
    v_and_b32 v83, 0xffff0000, v67
    v_and_b32 v84, 0xffff0000, v34
    v_mul_f32 v84, v83, v84
    v_cvt_pk_bf16_f32 v84, v84, v84
    v_lshlrev_b32 v84, 16, v84
    v_and_b32 v85, 0xffff0000, v38
    v_mul_f32 v85, v82, v85
    v_cvt_pk_bf16_f32 v85, v85, v85
    v_lshlrev_b32 v85, 16, v85
    v_add_f32 v84, v84, v85
    v_cvt_pk_bf16_f32 v84, v84, v84
    v_lshlrev_b32 v84, 16, v84
    v_and_b32 v85, 0xffff0000, v42
    v_mul_f32 v85, v81, v85
    v_cvt_pk_bf16_f32 v85, v85, v85
    v_lshlrev_b32 v85, 16, v85
    v_add_f32 v84, v84, v85
    v_cvt_pk_bf16_f32 v84, v84, v84
    v_lshlrev_b32 v84, 16, v84
    v_and_b32 v85, 0xffff0000, v46
    v_mul_f32 v85, v80, v85
    v_cvt_pk_bf16_f32 v85, v85, v85
    v_lshlrev_b32 v85, 16, v85
    v_add_f32 v84, v84, v85
    v_cvt_pk_bf16_f32 v84, v84, v84
    v_lshlrev_b32 v84, 16, v84
    v_and_b32 v85, 0xffff0000, v54
    v_mul_f32 v84, v84, v85
    v_cvt_pk_bf16_f32 v84, v84, v84
    ds_write_b16 v7, v84 offset:784
    v_lshlrev_b32 v80, 16, v68
    v_and_b32 v81, 0xffff0000, v68
    v_lshlrev_b32 v82, 16, v69
    v_and_b32 v83, 0xffff0000, v69
    v_lshlrev_b32 v84, 16, v35
    v_mul_f32 v84, v83, v84
    v_cvt_pk_bf16_f32 v84, v84, v84
    v_lshlrev_b32 v84, 16, v84
    v_lshlrev_b32 v85, 16, v39
    v_mul_f32 v85, v82, v85
    v_cvt_pk_bf16_f32 v85, v85, v85
    v_lshlrev_b32 v85, 16, v85
    v_add_f32 v84, v84, v85
    v_cvt_pk_bf16_f32 v84, v84, v84
    v_lshlrev_b32 v84, 16, v84
    v_lshlrev_b32 v85, 16, v43
    v_mul_f32 v85, v81, v85
    v_cvt_pk_bf16_f32 v85, v85, v85
    v_lshlrev_b32 v85, 16, v85
    v_add_f32 v84, v84, v85
    v_cvt_pk_bf16_f32 v84, v84, v84
    v_lshlrev_b32 v84, 16, v84
    v_lshlrev_b32 v85, 16, v47
    v_mul_f32 v85, v80, v85
    v_cvt_pk_bf16_f32 v85, v85, v85
    v_lshlrev_b32 v85, 16, v85
    v_add_f32 v84, v84, v85
    v_cvt_pk_bf16_f32 v84, v84, v84
    v_lshlrev_b32 v84, 16, v84
    v_lshlrev_b32 v85, 16, v55
    v_mul_f32 v84, v84, v85
    v_cvt_pk_bf16_f32 v84, v84, v84
    ds_write_b16 v7, v84 offset:928
    v_lshlrev_b32 v80, 16, v70
    v_and_b32 v81, 0xffff0000, v70
    v_lshlrev_b32 v82, 16, v71
    v_and_b32 v83, 0xffff0000, v71
    v_and_b32 v84, 0xffff0000, v35
    v_mul_f32 v84, v83, v84
    v_cvt_pk_bf16_f32 v84, v84, v84
    v_lshlrev_b32 v84, 16, v84
    v_and_b32 v85, 0xffff0000, v39
    v_mul_f32 v85, v82, v85
    v_cvt_pk_bf16_f32 v85, v85, v85
    v_lshlrev_b32 v85, 16, v85
    v_add_f32 v84, v84, v85
    v_cvt_pk_bf16_f32 v84, v84, v84
    v_lshlrev_b32 v84, 16, v84
    v_and_b32 v85, 0xffff0000, v43
    v_mul_f32 v85, v81, v85
    v_cvt_pk_bf16_f32 v85, v85, v85
    v_lshlrev_b32 v85, 16, v85
    v_add_f32 v84, v84, v85
    v_cvt_pk_bf16_f32 v84, v84, v84
    v_lshlrev_b32 v84, 16, v84
    v_and_b32 v85, 0xffff0000, v47
    v_mul_f32 v85, v80, v85
    v_cvt_pk_bf16_f32 v85, v85, v85
    v_lshlrev_b32 v85, 16, v85
    v_add_f32 v84, v84, v85
    v_cvt_pk_bf16_f32 v84, v84, v84
    v_lshlrev_b32 v84, 16, v84
    v_and_b32 v85, 0xffff0000, v55
    v_mul_f32 v84, v84, v85
    v_cvt_pk_bf16_f32 v84, v84, v84
    ds_write_b16 v7, v84 offset:1072
    s_waitcnt lgkmcnt(0)
    s_barrier
    v_add_u32 v8, 0, v0
    v_lshrrev_b32 v9, 3, v8
    v_and_b32 v10, 7, v8
    v_mul_u32_u24 v11, 144, v9
    v_lshl_add_u32 v11, v10, 4, v11
    ds_read_b128 v[16:19], v11
    v_add_u32 v9, s41, v9
    v_lshlrev_b32 v9, 12, v9
    v_lshl_add_u32 v9, v10, 4, v9
    s_lshl_b32 s42, s40, 1
    s_add_u32 s42, s42, 12582912
    v_add_u32 v12, s42, v9
    v_add_u32 v8, 256, v0
    v_lshrrev_b32 v9, 3, v8
    v_and_b32 v10, 7, v8
    v_mul_u32_u24 v11, 144, v9
    v_lshl_add_u32 v11, v10, 4, v11
    ds_read_b128 v[20:23], v11
    v_add_u32 v9, s41, v9
    v_lshlrev_b32 v9, 12, v9
    v_lshl_add_u32 v9, v10, 4, v9
    s_lshl_b32 s42, s40, 1
    s_add_u32 s42, s42, 12582912
    v_add_u32 v13, s42, v9
    s_waitcnt lgkmcnt(0)
    buffer_store_dwordx4 v[16:19], v12, s[24:27], 0 offen
    buffer_store_dwordx4 v[20:23], v13, s[24:27], 0 offen
    s_endpgm
K1_GEMM:
    s_mov_b32 s28, s4
    s_and_b32 s29, s5, 0xffff
    s_mov_b32 s30, 2097152
    s_mov_b32 s31, 0x00020000
    s_mov_b32 s32, s16
    s_and_b32 s33, s17, 0xffff
    s_mov_b32 s34, 1572864
    s_mov_b32 s35, 0x00020000
    s_mul_i32 s36, s2, 2731
    s_lshr_b32 s36, s36, 16
    s_mul_i32 s37, s36, 24
    s_sub_u32 s37, s2, s37
    s_lshl_b32 s38, s37, 7
    s_lshl_b32 s39, s36, 17
    v_lshrrev_b32 v3, 4, v0
    v_and_b32 v4, 15, v0
    v_lshlrev_b32 v5, 10, v3
    v_lshl_add_u32 v5, v4, 4, v5
    v_mul_u32_u24 v7, 272, v3
    v_lshl_add_u32 v7, v4, 4, v7
    v_lshrrev_b32 v3, 3, v0
    v_and_b32 v4, 7, v0
    v_mul_u32_u24 v6, 3072, v3
    v_lshl_add_u32 v6, v4, 4, v6
    v_mul_u32_u24 v18, 144, v3
    v_lshl_add_u32 v18, v4, 4, v18
    v_add_u32 v18, 34816, v18
    s_add_u32 s40, s39, 0
    buffer_load_dwordx4 v[96:99], v5, s[28:31], s40 offen
    s_add_u32 s40, s39, 16384
    buffer_load_dwordx4 v[100:103], v5, s[28:31], s40 offen
    s_add_u32 s40, s39, 32768
    buffer_load_dwordx4 v[104:107], v5, s[28:31], s40 offen
    s_add_u32 s40, s39, 49152
    buffer_load_dwordx4 v[108:111], v5, s[28:31], s40 offen
    s_add_u32 s40, s39, 65536
    buffer_load_dwordx4 v[112:115], v5, s[28:31], s40 offen
    s_add_u32 s40, s39, 81920
    buffer_load_dwordx4 v[116:119], v5, s[28:31], s40 offen
    s_add_u32 s40, s39, 98304
    buffer_load_dwordx4 v[120:123], v5, s[28:31], s40 offen
    s_add_u32 s40, s39, 114688
    buffer_load_dwordx4 v[124:127], v5, s[28:31], s40 offen
    s_add_u32 s40, s38, 0
    buffer_load_dwordx4 v[128:131], v6, s[32:35], s40 offen
    s_add_u32 s40, s38, 98304
    buffer_load_dwordx4 v[132:135], v6, s[32:35], s40 offen
    s_add_u32 s40, s38, 196608
    buffer_load_dwordx4 v[136:139], v6, s[32:35], s40 offen
    s_add_u32 s40, s38, 294912
    buffer_load_dwordx4 v[140:143], v6, s[32:35], s40 offen
    v_and_b32 v8, 31, v1
    v_lshrrev_b32 v9, 5, v1
    v_lshl_add_u32 v12, v2, 5, v8
    v_mul_u32_u24 v12, 272, v12
    v_lshl_add_u32 v12, v9, 4, v12
    v_lshrrev_b32 v13, 4, v1
    v_and_b32 v14, 15, v1
    v_lshrrev_b32 v15, 1, v13
    v_lshlrev_b32 v15, 3, v15
    v_lshrrev_b32 v16, 2, v14
    v_add_u32 v15, v15, v16
    v_mul_u32_u24 v15, 144, v15
    v_and_b32 v16, 1, v13
    v_lshlrev_b32 v16, 5, v16
    v_and_b32 v17, 3, v14
    v_lshl_add_u32 v16, v17, 3, v16
    v_add_u32 v15, v15, v16
    v_add_u32 v15, 34816, v15
    v_mov_b32 v64, 0
    v_mov_b32 v65, 0
    v_mov_b32 v66, 0
    v_mov_b32 v67, 0
    v_mov_b32 v68, 0
    v_mov_b32 v69, 0
    v_mov_b32 v70, 0
    v_mov_b32 v71, 0
    v_mov_b32 v72, 0
    v_mov_b32 v73, 0
    v_mov_b32 v74, 0
    v_mov_b32 v75, 0
    v_mov_b32 v76, 0
    v_mov_b32 v77, 0
    v_mov_b32 v78, 0
    v_mov_b32 v79, 0
    v_mov_b32 v80, 0
    v_mov_b32 v81, 0
    v_mov_b32 v82, 0
    v_mov_b32 v83, 0
    v_mov_b32 v84, 0
    v_mov_b32 v85, 0
    v_mov_b32 v86, 0
    v_mov_b32 v87, 0
    v_mov_b32 v88, 0
    v_mov_b32 v89, 0
    v_mov_b32 v90, 0
    v_mov_b32 v91, 0
    v_mov_b32 v92, 0
    v_mov_b32 v93, 0
    v_mov_b32 v94, 0
    v_mov_b32 v95, 0
    s_cmp_ge_u32 s37, 16
    s_cbranch_scc1 K1_GEMM_V
    s_waitcnt vmcnt(11)
    ds_write_b128 v7, v[96:99] offset:0
    s_waitcnt vmcnt(10)
    ds_write_b128 v7, v[100:103] offset:4352
    s_waitcnt vmcnt(9)
    ds_write_b128 v7, v[104:107] offset:8704
    s_waitcnt vmcnt(8)
    ds_write_b128 v7, v[108:111] offset:13056
    s_waitcnt vmcnt(7)
    ds_write_b128 v7, v[112:115] offset:17408
    s_waitcnt vmcnt(6)
    ds_write_b128 v7, v[116:119] offset:21760
    s_waitcnt vmcnt(5)
    ds_write_b128 v7, v[120:123] offset:26112
    s_waitcnt vmcnt(4)
    ds_write_b128 v7, v[124:127] offset:30464
    s_waitcnt vmcnt(3)
    ds_write_b128 v18, v[128:131] offset:0
    s_waitcnt vmcnt(2)
    ds_write_b128 v18, v[132:135] offset:4608
    s_waitcnt vmcnt(1)
    ds_write_b128 v18, v[136:139] offset:9216
    s_waitcnt vmcnt(0)
    ds_write_b128 v18, v[140:143] offset:13824
    s_waitcnt lgkmcnt(0)
    s_barrier
    s_add_u32 s40, s39, 256
    buffer_load_dwordx4 v[96:99], v5, s[28:31], s40 offen
    s_add_u32 s40, s39, 16640
    buffer_load_dwordx4 v[100:103], v5, s[28:31], s40 offen
    s_add_u32 s40, s39, 33024
    buffer_load_dwordx4 v[104:107], v5, s[28:31], s40 offen
    s_add_u32 s40, s39, 49408
    buffer_load_dwordx4 v[108:111], v5, s[28:31], s40 offen
    s_add_u32 s40, s39, 65792
    buffer_load_dwordx4 v[112:115], v5, s[28:31], s40 offen
    s_add_u32 s40, s39, 82176
    buffer_load_dwordx4 v[116:119], v5, s[28:31], s40 offen
    s_add_u32 s40, s39, 98560
    buffer_load_dwordx4 v[120:123], v5, s[28:31], s40 offen
    s_add_u32 s40, s39, 114944
    buffer_load_dwordx4 v[124:127], v5, s[28:31], s40 offen
    s_add_u32 s40, s38, 393216
    buffer_load_dwordx4 v[128:131], v6, s[32:35], s40 offen
    s_add_u32 s40, s38, 491520
    buffer_load_dwordx4 v[132:135], v6, s[32:35], s40 offen
    s_add_u32 s40, s38, 589824
    buffer_load_dwordx4 v[136:139], v6, s[32:35], s40 offen
    s_add_u32 s40, s38, 688128
    buffer_load_dwordx4 v[140:143], v6, s[32:35], s40 offen
    ds_read_b128 v[32:35], v12 offset:0
    ds_read_b64_tr_b16 v[36:37], v15 offset:0
    ds_read_b64_tr_b16 v[38:39], v15 offset:576
    ds_read_b64_tr_b16 v[40:41], v15 offset:64
    ds_read_b64_tr_b16 v[42:43], v15 offset:640
    ds_read_b128 v[44:47], v12 offset:32
    ds_read_b64_tr_b16 v[48:49], v15 offset:2304
    ds_read_b64_tr_b16 v[50:51], v15 offset:2880
    ds_read_b64_tr_b16 v[52:53], v15 offset:2368
    ds_read_b64_tr_b16 v[54:55], v15 offset:2944
    s_waitcnt lgkmcnt(5)
    v_mfma_f32_32x32x16_bf16 v[64:79], v[36:39], v[32:35], v[64:79]
    v_mfma_f32_32x32x16_bf16 v[80:95], v[40:43], v[32:35], v[80:95]
    ds_read_b128 v[32:35], v12 offset:64
    ds_read_b64_tr_b16 v[36:37], v15 offset:4608
    ds_read_b64_tr_b16 v[38:39], v15 offset:5184
    ds_read_b64_tr_b16 v[40:41], v15 offset:4672
    ds_read_b64_tr_b16 v[42:43], v15 offset:5248
    s_waitcnt lgkmcnt(5)
    v_mfma_f32_32x32x16_bf16 v[64:79], v[48:51], v[44:47], v[64:79]
    v_mfma_f32_32x32x16_bf16 v[80:95], v[52:55], v[44:47], v[80:95]
    ds_read_b128 v[44:47], v12 offset:96
    ds_read_b64_tr_b16 v[48:49], v15 offset:6912
    ds_read_b64_tr_b16 v[50:51], v15 offset:7488
    ds_read_b64_tr_b16 v[52:53], v15 offset:6976
    ds_read_b64_tr_b16 v[54:55], v15 offset:7552
    s_waitcnt lgkmcnt(5)
    v_mfma_f32_32x32x16_bf16 v[64:79], v[36:39], v[32:35], v[64:79]
    v_mfma_f32_32x32x16_bf16 v[80:95], v[40:43], v[32:35], v[80:95]
    ds_read_b128 v[32:35], v12 offset:128
    ds_read_b64_tr_b16 v[36:37], v15 offset:9216
    ds_read_b64_tr_b16 v[38:39], v15 offset:9792
    ds_read_b64_tr_b16 v[40:41], v15 offset:9280
    ds_read_b64_tr_b16 v[42:43], v15 offset:9856
    s_waitcnt lgkmcnt(5)
    v_mfma_f32_32x32x16_bf16 v[64:79], v[48:51], v[44:47], v[64:79]
    v_mfma_f32_32x32x16_bf16 v[80:95], v[52:55], v[44:47], v[80:95]
    ds_read_b128 v[44:47], v12 offset:160
    ds_read_b64_tr_b16 v[48:49], v15 offset:11520
    ds_read_b64_tr_b16 v[50:51], v15 offset:12096
    ds_read_b64_tr_b16 v[52:53], v15 offset:11584
    ds_read_b64_tr_b16 v[54:55], v15 offset:12160
    s_waitcnt lgkmcnt(5)
    v_mfma_f32_32x32x16_bf16 v[64:79], v[36:39], v[32:35], v[64:79]
    v_mfma_f32_32x32x16_bf16 v[80:95], v[40:43], v[32:35], v[80:95]
    ds_read_b128 v[32:35], v12 offset:192
    ds_read_b64_tr_b16 v[36:37], v15 offset:13824
    ds_read_b64_tr_b16 v[38:39], v15 offset:14400
    ds_read_b64_tr_b16 v[40:41], v15 offset:13888
    ds_read_b64_tr_b16 v[42:43], v15 offset:14464
    s_waitcnt lgkmcnt(5)
    v_mfma_f32_32x32x16_bf16 v[64:79], v[48:51], v[44:47], v[64:79]
    v_mfma_f32_32x32x16_bf16 v[80:95], v[52:55], v[44:47], v[80:95]
    ds_read_b128 v[44:47], v12 offset:224
    ds_read_b64_tr_b16 v[48:49], v15 offset:16128
    ds_read_b64_tr_b16 v[50:51], v15 offset:16704
    ds_read_b64_tr_b16 v[52:53], v15 offset:16192
    ds_read_b64_tr_b16 v[54:55], v15 offset:16768
    s_waitcnt lgkmcnt(5)
    v_mfma_f32_32x32x16_bf16 v[64:79], v[36:39], v[32:35], v[64:79]
    v_mfma_f32_32x32x16_bf16 v[80:95], v[40:43], v[32:35], v[80:95]
    s_waitcnt lgkmcnt(0)
    v_mfma_f32_32x32x16_bf16 v[64:79], v[48:51], v[44:47], v[64:79]
    v_mfma_f32_32x32x16_bf16 v[80:95], v[52:55], v[44:47], v[80:95]
    s_barrier
    s_waitcnt vmcnt(11)
    ds_write_b128 v7, v[96:99] offset:0
    s_waitcnt vmcnt(10)
    ds_write_b128 v7, v[100:103] offset:4352
    s_waitcnt vmcnt(9)
    ds_write_b128 v7, v[104:107] offset:8704
    s_waitcnt vmcnt(8)
    ds_write_b128 v7, v[108:111] offset:13056
    s_waitcnt vmcnt(7)
    ds_write_b128 v7, v[112:115] offset:17408
    s_waitcnt vmcnt(6)
    ds_write_b128 v7, v[116:119] offset:21760
    s_waitcnt vmcnt(5)
    ds_write_b128 v7, v[120:123] offset:26112
    s_waitcnt vmcnt(4)
    ds_write_b128 v7, v[124:127] offset:30464
    s_waitcnt vmcnt(3)
    ds_write_b128 v18, v[128:131] offset:0
    s_waitcnt vmcnt(2)
    ds_write_b128 v18, v[132:135] offset:4608
    s_waitcnt vmcnt(1)
    ds_write_b128 v18, v[136:139] offset:9216
    s_waitcnt vmcnt(0)
    ds_write_b128 v18, v[140:143] offset:13824
    s_waitcnt lgkmcnt(0)
    s_barrier
    s_add_u32 s40, s39, 512
    buffer_load_dwordx4 v[96:99], v5, s[28:31], s40 offen
    s_add_u32 s40, s39, 16896
    buffer_load_dwordx4 v[100:103], v5, s[28:31], s40 offen
    s_add_u32 s40, s39, 33280
    buffer_load_dwordx4 v[104:107], v5, s[28:31], s40 offen
    s_add_u32 s40, s39, 49664
    buffer_load_dwordx4 v[108:111], v5, s[28:31], s40 offen
    s_add_u32 s40, s39, 66048
    buffer_load_dwordx4 v[112:115], v5, s[28:31], s40 offen
    s_add_u32 s40, s39, 82432
    buffer_load_dwordx4 v[116:119], v5, s[28:31], s40 offen
    s_add_u32 s40, s39, 98816
    buffer_load_dwordx4 v[120:123], v5, s[28:31], s40 offen
    s_add_u32 s40, s39, 115200
    buffer_load_dwordx4 v[124:127], v5, s[28:31], s40 offen
    s_add_u32 s40, s38, 786432
    buffer_load_dwordx4 v[128:131], v6, s[32:35], s40 offen
    s_add_u32 s40, s38, 884736
    buffer_load_dwordx4 v[132:135], v6, s[32:35], s40 offen
    s_add_u32 s40, s38, 983040
    buffer_load_dwordx4 v[136:139], v6, s[32:35], s40 offen
    s_add_u32 s40, s38, 1081344
    buffer_load_dwordx4 v[140:143], v6, s[32:35], s40 offen
    ds_read_b128 v[32:35], v12 offset:0
    ds_read_b64_tr_b16 v[36:37], v15 offset:0
    ds_read_b64_tr_b16 v[38:39], v15 offset:576
    ds_read_b64_tr_b16 v[40:41], v15 offset:64
    ds_read_b64_tr_b16 v[42:43], v15 offset:640
    ds_read_b128 v[44:47], v12 offset:32
    ds_read_b64_tr_b16 v[48:49], v15 offset:2304
    ds_read_b64_tr_b16 v[50:51], v15 offset:2880
    ds_read_b64_tr_b16 v[52:53], v15 offset:2368
    ds_read_b64_tr_b16 v[54:55], v15 offset:2944
    s_waitcnt lgkmcnt(5)
    v_mfma_f32_32x32x16_bf16 v[64:79], v[36:39], v[32:35], v[64:79]
    v_mfma_f32_32x32x16_bf16 v[80:95], v[40:43], v[32:35], v[80:95]
    ds_read_b128 v[32:35], v12 offset:64
    ds_read_b64_tr_b16 v[36:37], v15 offset:4608
    ds_read_b64_tr_b16 v[38:39], v15 offset:5184
    ds_read_b64_tr_b16 v[40:41], v15 offset:4672
    ds_read_b64_tr_b16 v[42:43], v15 offset:5248
    s_waitcnt lgkmcnt(5)
    v_mfma_f32_32x32x16_bf16 v[64:79], v[48:51], v[44:47], v[64:79]
    v_mfma_f32_32x32x16_bf16 v[80:95], v[52:55], v[44:47], v[80:95]
    ds_read_b128 v[44:47], v12 offset:96
    ds_read_b64_tr_b16 v[48:49], v15 offset:6912
    ds_read_b64_tr_b16 v[50:51], v15 offset:7488
    ds_read_b64_tr_b16 v[52:53], v15 offset:6976
    ds_read_b64_tr_b16 v[54:55], v15 offset:7552
    s_waitcnt lgkmcnt(5)
    v_mfma_f32_32x32x16_bf16 v[64:79], v[36:39], v[32:35], v[64:79]
    v_mfma_f32_32x32x16_bf16 v[80:95], v[40:43], v[32:35], v[80:95]
    ds_read_b128 v[32:35], v12 offset:128
    ds_read_b64_tr_b16 v[36:37], v15 offset:9216
    ds_read_b64_tr_b16 v[38:39], v15 offset:9792
    ds_read_b64_tr_b16 v[40:41], v15 offset:9280
    ds_read_b64_tr_b16 v[42:43], v15 offset:9856
    s_waitcnt lgkmcnt(5)
    v_mfma_f32_32x32x16_bf16 v[64:79], v[48:51], v[44:47], v[64:79]
    v_mfma_f32_32x32x16_bf16 v[80:95], v[52:55], v[44:47], v[80:95]
    ds_read_b128 v[44:47], v12 offset:160
    ds_read_b64_tr_b16 v[48:49], v15 offset:11520
    ds_read_b64_tr_b16 v[50:51], v15 offset:12096
    ds_read_b64_tr_b16 v[52:53], v15 offset:11584
    ds_read_b64_tr_b16 v[54:55], v15 offset:12160
    s_waitcnt lgkmcnt(5)
    v_mfma_f32_32x32x16_bf16 v[64:79], v[36:39], v[32:35], v[64:79]
    v_mfma_f32_32x32x16_bf16 v[80:95], v[40:43], v[32:35], v[80:95]
    ds_read_b128 v[32:35], v12 offset:192
    ds_read_b64_tr_b16 v[36:37], v15 offset:13824
    ds_read_b64_tr_b16 v[38:39], v15 offset:14400
    ds_read_b64_tr_b16 v[40:41], v15 offset:13888
    ds_read_b64_tr_b16 v[42:43], v15 offset:14464
    s_waitcnt lgkmcnt(5)
    v_mfma_f32_32x32x16_bf16 v[64:79], v[48:51], v[44:47], v[64:79]
    v_mfma_f32_32x32x16_bf16 v[80:95], v[52:55], v[44:47], v[80:95]
    ds_read_b128 v[44:47], v12 offset:224
    ds_read_b64_tr_b16 v[48:49], v15 offset:16128
    ds_read_b64_tr_b16 v[50:51], v15 offset:16704
    ds_read_b64_tr_b16 v[52:53], v15 offset:16192
    ds_read_b64_tr_b16 v[54:55], v15 offset:16768
    s_waitcnt lgkmcnt(5)
    v_mfma_f32_32x32x16_bf16 v[64:79], v[36:39], v[32:35], v[64:79]
    v_mfma_f32_32x32x16_bf16 v[80:95], v[40:43], v[32:35], v[80:95]
    s_waitcnt lgkmcnt(0)
    v_mfma_f32_32x32x16_bf16 v[64:79], v[48:51], v[44:47], v[64:79]
    v_mfma_f32_32x32x16_bf16 v[80:95], v[52:55], v[44:47], v[80:95]
    s_barrier
    s_waitcnt vmcnt(11)
    ds_write_b128 v7, v[96:99] offset:0
    s_waitcnt vmcnt(10)
    ds_write_b128 v7, v[100:103] offset:4352
    s_waitcnt vmcnt(9)
    ds_write_b128 v7, v[104:107] offset:8704
    s_waitcnt vmcnt(8)
    ds_write_b128 v7, v[108:111] offset:13056
    s_waitcnt vmcnt(7)
    ds_write_b128 v7, v[112:115] offset:17408
    s_waitcnt vmcnt(6)
    ds_write_b128 v7, v[116:119] offset:21760
    s_waitcnt vmcnt(5)
    ds_write_b128 v7, v[120:123] offset:26112
    s_waitcnt vmcnt(4)
    ds_write_b128 v7, v[124:127] offset:30464
    s_waitcnt vmcnt(3)
    ds_write_b128 v18, v[128:131] offset:0
    s_waitcnt vmcnt(2)
    ds_write_b128 v18, v[132:135] offset:4608
    s_waitcnt vmcnt(1)
    ds_write_b128 v18, v[136:139] offset:9216
    s_waitcnt vmcnt(0)
    ds_write_b128 v18, v[140:143] offset:13824
    s_waitcnt lgkmcnt(0)
    s_barrier
    s_add_u32 s40, s39, 768
    buffer_load_dwordx4 v[96:99], v5, s[28:31], s40 offen
    s_add_u32 s40, s39, 17152
    buffer_load_dwordx4 v[100:103], v5, s[28:31], s40 offen
    s_add_u32 s40, s39, 33536
    buffer_load_dwordx4 v[104:107], v5, s[28:31], s40 offen
    s_add_u32 s40, s39, 49920
    buffer_load_dwordx4 v[108:111], v5, s[28:31], s40 offen
    s_add_u32 s40, s39, 66304
    buffer_load_dwordx4 v[112:115], v5, s[28:31], s40 offen
    s_add_u32 s40, s39, 82688
    buffer_load_dwordx4 v[116:119], v5, s[28:31], s40 offen
    s_add_u32 s40, s39, 99072
    buffer_load_dwordx4 v[120:123], v5, s[28:31], s40 offen
    s_add_u32 s40, s39, 115456
    buffer_load_dwordx4 v[124:127], v5, s[28:31], s40 offen
    s_add_u32 s40, s38, 1179648
    buffer_load_dwordx4 v[128:131], v6, s[32:35], s40 offen
    s_add_u32 s40, s38, 1277952
    buffer_load_dwordx4 v[132:135], v6, s[32:35], s40 offen
    s_add_u32 s40, s38, 1376256
    buffer_load_dwordx4 v[136:139], v6, s[32:35], s40 offen
    s_add_u32 s40, s38, 1474560
    buffer_load_dwordx4 v[140:143], v6, s[32:35], s40 offen
    ds_read_b128 v[32:35], v12 offset:0
    ds_read_b64_tr_b16 v[36:37], v15 offset:0
    ds_read_b64_tr_b16 v[38:39], v15 offset:576
    ds_read_b64_tr_b16 v[40:41], v15 offset:64
    ds_read_b64_tr_b16 v[42:43], v15 offset:640
    ds_read_b128 v[44:47], v12 offset:32
    ds_read_b64_tr_b16 v[48:49], v15 offset:2304
    ds_read_b64_tr_b16 v[50:51], v15 offset:2880
    ds_read_b64_tr_b16 v[52:53], v15 offset:2368
    ds_read_b64_tr_b16 v[54:55], v15 offset:2944
    s_waitcnt lgkmcnt(5)
    v_mfma_f32_32x32x16_bf16 v[64:79], v[36:39], v[32:35], v[64:79]
    v_mfma_f32_32x32x16_bf16 v[80:95], v[40:43], v[32:35], v[80:95]
    ds_read_b128 v[32:35], v12 offset:64
    ds_read_b64_tr_b16 v[36:37], v15 offset:4608
    ds_read_b64_tr_b16 v[38:39], v15 offset:5184
    ds_read_b64_tr_b16 v[40:41], v15 offset:4672
    ds_read_b64_tr_b16 v[42:43], v15 offset:5248
    s_waitcnt lgkmcnt(5)
    v_mfma_f32_32x32x16_bf16 v[64:79], v[48:51], v[44:47], v[64:79]
    v_mfma_f32_32x32x16_bf16 v[80:95], v[52:55], v[44:47], v[80:95]
    ds_read_b128 v[44:47], v12 offset:96
    ds_read_b64_tr_b16 v[48:49], v15 offset:6912
    ds_read_b64_tr_b16 v[50:51], v15 offset:7488
    ds_read_b64_tr_b16 v[52:53], v15 offset:6976
    ds_read_b64_tr_b16 v[54:55], v15 offset:7552
    s_waitcnt lgkmcnt(5)
    v_mfma_f32_32x32x16_bf16 v[64:79], v[36:39], v[32:35], v[64:79]
    v_mfma_f32_32x32x16_bf16 v[80:95], v[40:43], v[32:35], v[80:95]
    ds_read_b128 v[32:35], v12 offset:128
    ds_read_b64_tr_b16 v[36:37], v15 offset:9216
    ds_read_b64_tr_b16 v[38:39], v15 offset:9792
    ds_read_b64_tr_b16 v[40:41], v15 offset:9280
    ds_read_b64_tr_b16 v[42:43], v15 offset:9856
    s_waitcnt lgkmcnt(5)
    v_mfma_f32_32x32x16_bf16 v[64:79], v[48:51], v[44:47], v[64:79]
    v_mfma_f32_32x32x16_bf16 v[80:95], v[52:55], v[44:47], v[80:95]
    ds_read_b128 v[44:47], v12 offset:160
    ds_read_b64_tr_b16 v[48:49], v15 offset:11520
    ds_read_b64_tr_b16 v[50:51], v15 offset:12096
    ds_read_b64_tr_b16 v[52:53], v15 offset:11584
    ds_read_b64_tr_b16 v[54:55], v15 offset:12160
    s_waitcnt lgkmcnt(5)
    v_mfma_f32_32x32x16_bf16 v[64:79], v[36:39], v[32:35], v[64:79]
    v_mfma_f32_32x32x16_bf16 v[80:95], v[40:43], v[32:35], v[80:95]
    ds_read_b128 v[32:35], v12 offset:192
    ds_read_b64_tr_b16 v[36:37], v15 offset:13824
    ds_read_b64_tr_b16 v[38:39], v15 offset:14400
    ds_read_b64_tr_b16 v[40:41], v15 offset:13888
    ds_read_b64_tr_b16 v[42:43], v15 offset:14464
    s_waitcnt lgkmcnt(5)
    v_mfma_f32_32x32x16_bf16 v[64:79], v[48:51], v[44:47], v[64:79]
    v_mfma_f32_32x32x16_bf16 v[80:95], v[52:55], v[44:47], v[80:95]
    ds_read_b128 v[44:47], v12 offset:224
    ds_read_b64_tr_b16 v[48:49], v15 offset:16128
    ds_read_b64_tr_b16 v[50:51], v15 offset:16704
    ds_read_b64_tr_b16 v[52:53], v15 offset:16192
    ds_read_b64_tr_b16 v[54:55], v15 offset:16768
    s_waitcnt lgkmcnt(5)
    v_mfma_f32_32x32x16_bf16 v[64:79], v[36:39], v[32:35], v[64:79]
    v_mfma_f32_32x32x16_bf16 v[80:95], v[40:43], v[32:35], v[80:95]
    s_waitcnt lgkmcnt(0)
    v_mfma_f32_32x32x16_bf16 v[64:79], v[48:51], v[44:47], v[64:79]
    v_mfma_f32_32x32x16_bf16 v[80:95], v[52:55], v[44:47], v[80:95]
    s_barrier
    s_waitcnt vmcnt(11)
    ds_write_b128 v7, v[96:99] offset:0
    s_waitcnt vmcnt(10)
    ds_write_b128 v7, v[100:103] offset:4352
    s_waitcnt vmcnt(9)
    ds_write_b128 v7, v[104:107] offset:8704
    s_waitcnt vmcnt(8)
    ds_write_b128 v7, v[108:111] offset:13056
    s_waitcnt vmcnt(7)
    ds_write_b128 v7, v[112:115] offset:17408
    s_waitcnt vmcnt(6)
    ds_write_b128 v7, v[116:119] offset:21760
    s_waitcnt vmcnt(5)
    ds_write_b128 v7, v[120:123] offset:26112
    s_waitcnt vmcnt(4)
    ds_write_b128 v7, v[124:127] offset:30464
    s_waitcnt vmcnt(3)
    ds_write_b128 v18, v[128:131] offset:0
    s_waitcnt vmcnt(2)
    ds_write_b128 v18, v[132:135] offset:4608
    s_waitcnt vmcnt(1)
    ds_write_b128 v18, v[136:139] offset:9216
    s_waitcnt vmcnt(0)
    ds_write_b128 v18, v[140:143] offset:13824
    s_waitcnt lgkmcnt(0)
    s_barrier
    ds_read_b128 v[32:35], v12 offset:0
    ds_read_b64_tr_b16 v[36:37], v15 offset:0
    ds_read_b64_tr_b16 v[38:39], v15 offset:576
    ds_read_b64_tr_b16 v[40:41], v15 offset:64
    ds_read_b64_tr_b16 v[42:43], v15 offset:640
    ds_read_b128 v[44:47], v12 offset:32
    ds_read_b64_tr_b16 v[48:49], v15 offset:2304
    ds_read_b64_tr_b16 v[50:51], v15 offset:2880
    ds_read_b64_tr_b16 v[52:53], v15 offset:2368
    ds_read_b64_tr_b16 v[54:55], v15 offset:2944
    s_waitcnt lgkmcnt(5)
    v_mfma_f32_32x32x16_bf16 v[64:79], v[36:39], v[32:35], v[64:79]
    v_mfma_f32_32x32x16_bf16 v[80:95], v[40:43], v[32:35], v[80:95]
    ds_read_b128 v[32:35], v12 offset:64
    ds_read_b64_tr_b16 v[36:37], v15 offset:4608
    ds_read_b64_tr_b16 v[38:39], v15 offset:5184
    ds_read_b64_tr_b16 v[40:41], v15 offset:4672
    ds_read_b64_tr_b16 v[42:43], v15 offset:5248
    s_waitcnt lgkmcnt(5)
    v_mfma_f32_32x32x16_bf16 v[64:79], v[48:51], v[44:47], v[64:79]
    v_mfma_f32_32x32x16_bf16 v[80:95], v[52:55], v[44:47], v[80:95]
    ds_read_b128 v[44:47], v12 offset:96
    ds_read_b64_tr_b16 v[48:49], v15 offset:6912
    ds_read_b64_tr_b16 v[50:51], v15 offset:7488
    ds_read_b64_tr_b16 v[52:53], v15 offset:6976
    ds_read_b64_tr_b16 v[54:55], v15 offset:7552
    s_waitcnt lgkmcnt(5)
    v_mfma_f32_32x32x16_bf16 v[64:79], v[36:39], v[32:35], v[64:79]
    v_mfma_f32_32x32x16_bf16 v[80:95], v[40:43], v[32:35], v[80:95]
    ds_read_b128 v[32:35], v12 offset:128
    ds_read_b64_tr_b16 v[36:37], v15 offset:9216
    ds_read_b64_tr_b16 v[38:39], v15 offset:9792
    ds_read_b64_tr_b16 v[40:41], v15 offset:9280
    ds_read_b64_tr_b16 v[42:43], v15 offset:9856
    s_waitcnt lgkmcnt(5)
    v_mfma_f32_32x32x16_bf16 v[64:79], v[48:51], v[44:47], v[64:79]
    v_mfma_f32_32x32x16_bf16 v[80:95], v[52:55], v[44:47], v[80:95]
    ds_read_b128 v[44:47], v12 offset:160
    ds_read_b64_tr_b16 v[48:49], v15 offset:11520
    ds_read_b64_tr_b16 v[50:51], v15 offset:12096
    ds_read_b64_tr_b16 v[52:53], v15 offset:11584
    ds_read_b64_tr_b16 v[54:55], v15 offset:12160
    s_waitcnt lgkmcnt(5)
    v_mfma_f32_32x32x16_bf16 v[64:79], v[36:39], v[32:35], v[64:79]
    v_mfma_f32_32x32x16_bf16 v[80:95], v[40:43], v[32:35], v[80:95]
    ds_read_b128 v[32:35], v12 offset:192
    ds_read_b64_tr_b16 v[36:37], v15 offset:13824
    ds_read_b64_tr_b16 v[38:39], v15 offset:14400
    ds_read_b64_tr_b16 v[40:41], v15 offset:13888
    ds_read_b64_tr_b16 v[42:43], v15 offset:14464
    s_waitcnt lgkmcnt(5)
    v_mfma_f32_32x32x16_bf16 v[64:79], v[48:51], v[44:47], v[64:79]
    v_mfma_f32_32x32x16_bf16 v[80:95], v[52:55], v[44:47], v[80:95]
    ds_read_b128 v[44:47], v12 offset:224
    ds_read_b64_tr_b16 v[48:49], v15 offset:16128
    ds_read_b64_tr_b16 v[50:51], v15 offset:16704
    ds_read_b64_tr_b16 v[52:53], v15 offset:16192
    ds_read_b64_tr_b16 v[54:55], v15 offset:16768
    s_waitcnt lgkmcnt(5)
    v_mfma_f32_32x32x16_bf16 v[64:79], v[36:39], v[32:35], v[64:79]
    v_mfma_f32_32x32x16_bf16 v[80:95], v[40:43], v[32:35], v[80:95]
    s_waitcnt lgkmcnt(0)
    v_mfma_f32_32x32x16_bf16 v[64:79], v[48:51], v[44:47], v[64:79]
    v_mfma_f32_32x32x16_bf16 v[80:95], v[52:55], v[44:47], v[80:95]
    s_nop 7
    s_nop 7
    s_lshr_b32 s42, s37, 3
    s_lshl_b32 s42, s42, 21
    s_and_b32 s43, s37, 7
    s_lshl_b32 s43, s43, 18
    s_add_u32 s42, s42, s43
    s_lshl_b32 s43, s36, 12
    s_add_u32 s42, s42, s43
    v_lshl_add_u32 v12, v2, 5, v8
    v_lshlrev_b32 v12, 5, v12
    v_lshl_add_u32 v12, v9, 3, v12
    v_add_u32 v12, s42, v12
    v_cvt_pk_bf16_f32 v48, v64, v65
    v_cvt_pk_bf16_f32 v49, v66, v67
    s_mov_b32 s43, 0
    buffer_store_dwordx2 v[48:49], v12, s[24:27], s43 offen offset:0
    v_cvt_pk_bf16_f32 v50, v68, v69
    v_cvt_pk_bf16_f32 v51, v70, v71
    s_mov_b32 s43, 0
    buffer_store_dwordx2 v[50:51], v12, s[24:27], s43 offen offset:16
    v_cvt_pk_bf16_f32 v48, v72, v73
    v_cvt_pk_bf16_f32 v49, v74, v75
    s_mov_b32 s43, 65536
    buffer_store_dwordx2 v[48:49], v12, s[24:27], s43 offen offset:0
    v_cvt_pk_bf16_f32 v50, v76, v77
    v_cvt_pk_bf16_f32 v51, v78, v79
    s_mov_b32 s43, 65536
    buffer_store_dwordx2 v[50:51], v12, s[24:27], s43 offen offset:16
    v_cvt_pk_bf16_f32 v48, v80, v81
    v_cvt_pk_bf16_f32 v49, v82, v83
    s_mov_b32 s43, 131072
    buffer_store_dwordx2 v[48:49], v12, s[24:27], s43 offen offset:0
    v_cvt_pk_bf16_f32 v50, v84, v85
    v_cvt_pk_bf16_f32 v51, v86, v87
    s_mov_b32 s43, 131072
    buffer_store_dwordx2 v[50:51], v12, s[24:27], s43 offen offset:16
    v_cvt_pk_bf16_f32 v48, v88, v89
    v_cvt_pk_bf16_f32 v49, v90, v91
    s_mov_b32 s43, 196608
    buffer_store_dwordx2 v[48:49], v12, s[24:27], s43 offen offset:0
    v_cvt_pk_bf16_f32 v50, v92, v93
    v_cvt_pk_bf16_f32 v51, v94, v95
    s_mov_b32 s43, 196608
    buffer_store_dwordx2 v[50:51], v12, s[24:27], s43 offen offset:16
    s_endpgm
K1_GEMM_V:
    s_waitcnt vmcnt(11)
    ds_write_b128 v7, v[96:99] offset:0
    s_waitcnt vmcnt(10)
    ds_write_b128 v7, v[100:103] offset:4352
    s_waitcnt vmcnt(9)
    ds_write_b128 v7, v[104:107] offset:8704
    s_waitcnt vmcnt(8)
    ds_write_b128 v7, v[108:111] offset:13056
    s_waitcnt vmcnt(7)
    ds_write_b128 v7, v[112:115] offset:17408
    s_waitcnt vmcnt(6)
    ds_write_b128 v7, v[116:119] offset:21760
    s_waitcnt vmcnt(5)
    ds_write_b128 v7, v[120:123] offset:26112
    s_waitcnt vmcnt(4)
    ds_write_b128 v7, v[124:127] offset:30464
    s_waitcnt vmcnt(3)
    ds_write_b128 v18, v[128:131] offset:0
    s_waitcnt vmcnt(2)
    ds_write_b128 v18, v[132:135] offset:4608
    s_waitcnt vmcnt(1)
    ds_write_b128 v18, v[136:139] offset:9216
    s_waitcnt vmcnt(0)
    ds_write_b128 v18, v[140:143] offset:13824
    s_waitcnt lgkmcnt(0)
    s_barrier
    s_add_u32 s40, s39, 256
    buffer_load_dwordx4 v[96:99], v5, s[28:31], s40 offen
    s_add_u32 s40, s39, 16640
    buffer_load_dwordx4 v[100:103], v5, s[28:31], s40 offen
    s_add_u32 s40, s39, 33024
    buffer_load_dwordx4 v[104:107], v5, s[28:31], s40 offen
    s_add_u32 s40, s39, 49408
    buffer_load_dwordx4 v[108:111], v5, s[28:31], s40 offen
    s_add_u32 s40, s39, 65792
    buffer_load_dwordx4 v[112:115], v5, s[28:31], s40 offen
    s_add_u32 s40, s39, 82176
    buffer_load_dwordx4 v[116:119], v5, s[28:31], s40 offen
    s_add_u32 s40, s39, 98560
    buffer_load_dwordx4 v[120:123], v5, s[28:31], s40 offen
    s_add_u32 s40, s39, 114944
    buffer_load_dwordx4 v[124:127], v5, s[28:31], s40 offen
    s_add_u32 s40, s38, 393216
    buffer_load_dwordx4 v[128:131], v6, s[32:35], s40 offen
    s_add_u32 s40, s38, 491520
    buffer_load_dwordx4 v[132:135], v6, s[32:35], s40 offen
    s_add_u32 s40, s38, 589824
    buffer_load_dwordx4 v[136:139], v6, s[32:35], s40 offen
    s_add_u32 s40, s38, 688128
    buffer_load_dwordx4 v[140:143], v6, s[32:35], s40 offen
    ds_read_b128 v[32:35], v12 offset:0
    ds_read_b64_tr_b16 v[36:37], v15 offset:0
    ds_read_b64_tr_b16 v[38:39], v15 offset:576
    ds_read_b64_tr_b16 v[40:41], v15 offset:64
    ds_read_b64_tr_b16 v[42:43], v15 offset:640
    ds_read_b128 v[44:47], v12 offset:32
    ds_read_b64_tr_b16 v[48:49], v15 offset:2304
    ds_read_b64_tr_b16 v[50:51], v15 offset:2880
    ds_read_b64_tr_b16 v[52:53], v15 offset:2368
    ds_read_b64_tr_b16 v[54:55], v15 offset:2944
    s_waitcnt lgkmcnt(5)
    v_mfma_f32_32x32x16_bf16 v[64:79], v[32:35], v[36:39], v[64:79]
    v_mfma_f32_32x32x16_bf16 v[80:95], v[32:35], v[40:43], v[80:95]
    ds_read_b128 v[32:35], v12 offset:64
    ds_read_b64_tr_b16 v[36:37], v15 offset:4608
    ds_read_b64_tr_b16 v[38:39], v15 offset:5184
    ds_read_b64_tr_b16 v[40:41], v15 offset:4672
    ds_read_b64_tr_b16 v[42:43], v15 offset:5248
    s_waitcnt lgkmcnt(5)
    v_mfma_f32_32x32x16_bf16 v[64:79], v[44:47], v[48:51], v[64:79]
    v_mfma_f32_32x32x16_bf16 v[80:95], v[44:47], v[52:55], v[80:95]
    ds_read_b128 v[44:47], v12 offset:96
    ds_read_b64_tr_b16 v[48:49], v15 offset:6912
    ds_read_b64_tr_b16 v[50:51], v15 offset:7488
    ds_read_b64_tr_b16 v[52:53], v15 offset:6976
    ds_read_b64_tr_b16 v[54:55], v15 offset:7552
    s_waitcnt lgkmcnt(5)
    v_mfma_f32_32x32x16_bf16 v[64:79], v[32:35], v[36:39], v[64:79]
    v_mfma_f32_32x32x16_bf16 v[80:95], v[32:35], v[40:43], v[80:95]
    ds_read_b128 v[32:35], v12 offset:128
    ds_read_b64_tr_b16 v[36:37], v15 offset:9216
    ds_read_b64_tr_b16 v[38:39], v15 offset:9792
    ds_read_b64_tr_b16 v[40:41], v15 offset:9280
    ds_read_b64_tr_b16 v[42:43], v15 offset:9856
    s_waitcnt lgkmcnt(5)
    v_mfma_f32_32x32x16_bf16 v[64:79], v[44:47], v[48:51], v[64:79]
    v_mfma_f32_32x32x16_bf16 v[80:95], v[44:47], v[52:55], v[80:95]
    ds_read_b128 v[44:47], v12 offset:160
    ds_read_b64_tr_b16 v[48:49], v15 offset:11520
    ds_read_b64_tr_b16 v[50:51], v15 offset:12096
    ds_read_b64_tr_b16 v[52:53], v15 offset:11584
    ds_read_b64_tr_b16 v[54:55], v15 offset:12160
    s_waitcnt lgkmcnt(5)
    v_mfma_f32_32x32x16_bf16 v[64:79], v[32:35], v[36:39], v[64:79]
    v_mfma_f32_32x32x16_bf16 v[80:95], v[32:35], v[40:43], v[80:95]
    ds_read_b128 v[32:35], v12 offset:192
    ds_read_b64_tr_b16 v[36:37], v15 offset:13824
    ds_read_b64_tr_b16 v[38:39], v15 offset:14400
    ds_read_b64_tr_b16 v[40:41], v15 offset:13888
    ds_read_b64_tr_b16 v[42:43], v15 offset:14464
    s_waitcnt lgkmcnt(5)
    v_mfma_f32_32x32x16_bf16 v[64:79], v[44:47], v[48:51], v[64:79]
    v_mfma_f32_32x32x16_bf16 v[80:95], v[44:47], v[52:55], v[80:95]
    ds_read_b128 v[44:47], v12 offset:224
    ds_read_b64_tr_b16 v[48:49], v15 offset:16128
    ds_read_b64_tr_b16 v[50:51], v15 offset:16704
    ds_read_b64_tr_b16 v[52:53], v15 offset:16192
    ds_read_b64_tr_b16 v[54:55], v15 offset:16768
    s_waitcnt lgkmcnt(5)
    v_mfma_f32_32x32x16_bf16 v[64:79], v[32:35], v[36:39], v[64:79]
    v_mfma_f32_32x32x16_bf16 v[80:95], v[32:35], v[40:43], v[80:95]
    s_waitcnt lgkmcnt(0)
    v_mfma_f32_32x32x16_bf16 v[64:79], v[44:47], v[48:51], v[64:79]
    v_mfma_f32_32x32x16_bf16 v[80:95], v[44:47], v[52:55], v[80:95]
    s_barrier
    s_waitcnt vmcnt(11)
    ds_write_b128 v7, v[96:99] offset:0
    s_waitcnt vmcnt(10)
    ds_write_b128 v7, v[100:103] offset:4352
    s_waitcnt vmcnt(9)
    ds_write_b128 v7, v[104:107] offset:8704
    s_waitcnt vmcnt(8)
    ds_write_b128 v7, v[108:111] offset:13056
    s_waitcnt vmcnt(7)
    ds_write_b128 v7, v[112:115] offset:17408
    s_waitcnt vmcnt(6)
    ds_write_b128 v7, v[116:119] offset:21760
    s_waitcnt vmcnt(5)
    ds_write_b128 v7, v[120:123] offset:26112
    s_waitcnt vmcnt(4)
    ds_write_b128 v7, v[124:127] offset:30464
    s_waitcnt vmcnt(3)
    ds_write_b128 v18, v[128:131] offset:0
    s_waitcnt vmcnt(2)
    ds_write_b128 v18, v[132:135] offset:4608
    s_waitcnt vmcnt(1)
    ds_write_b128 v18, v[136:139] offset:9216
    s_waitcnt vmcnt(0)
    ds_write_b128 v18, v[140:143] offset:13824
    s_waitcnt lgkmcnt(0)
    s_barrier
    s_add_u32 s40, s39, 512
    buffer_load_dwordx4 v[96:99], v5, s[28:31], s40 offen
    s_add_u32 s40, s39, 16896
    buffer_load_dwordx4 v[100:103], v5, s[28:31], s40 offen
    s_add_u32 s40, s39, 33280
    buffer_load_dwordx4 v[104:107], v5, s[28:31], s40 offen
    s_add_u32 s40, s39, 49664
    buffer_load_dwordx4 v[108:111], v5, s[28:31], s40 offen
    s_add_u32 s40, s39, 66048
    buffer_load_dwordx4 v[112:115], v5, s[28:31], s40 offen
    s_add_u32 s40, s39, 82432
    buffer_load_dwordx4 v[116:119], v5, s[28:31], s40 offen
    s_add_u32 s40, s39, 98816
    buffer_load_dwordx4 v[120:123], v5, s[28:31], s40 offen
    s_add_u32 s40, s39, 115200
    buffer_load_dwordx4 v[124:127], v5, s[28:31], s40 offen
    s_add_u32 s40, s38, 786432
    buffer_load_dwordx4 v[128:131], v6, s[32:35], s40 offen
    s_add_u32 s40, s38, 884736
    buffer_load_dwordx4 v[132:135], v6, s[32:35], s40 offen
    s_add_u32 s40, s38, 983040
    buffer_load_dwordx4 v[136:139], v6, s[32:35], s40 offen
    s_add_u32 s40, s38, 1081344
    buffer_load_dwordx4 v[140:143], v6, s[32:35], s40 offen
    ds_read_b128 v[32:35], v12 offset:0
    ds_read_b64_tr_b16 v[36:37], v15 offset:0
    ds_read_b64_tr_b16 v[38:39], v15 offset:576
    ds_read_b64_tr_b16 v[40:41], v15 offset:64
    ds_read_b64_tr_b16 v[42:43], v15 offset:640
    ds_read_b128 v[44:47], v12 offset:32
    ds_read_b64_tr_b16 v[48:49], v15 offset:2304
    ds_read_b64_tr_b16 v[50:51], v15 offset:2880
    ds_read_b64_tr_b16 v[52:53], v15 offset:2368
    ds_read_b64_tr_b16 v[54:55], v15 offset:2944
    s_waitcnt lgkmcnt(5)
    v_mfma_f32_32x32x16_bf16 v[64:79], v[32:35], v[36:39], v[64:79]
    v_mfma_f32_32x32x16_bf16 v[80:95], v[32:35], v[40:43], v[80:95]
    ds_read_b128 v[32:35], v12 offset:64
    ds_read_b64_tr_b16 v[36:37], v15 offset:4608
    ds_read_b64_tr_b16 v[38:39], v15 offset:5184
    ds_read_b64_tr_b16 v[40:41], v15 offset:4672
    ds_read_b64_tr_b16 v[42:43], v15 offset:5248
    s_waitcnt lgkmcnt(5)
    v_mfma_f32_32x32x16_bf16 v[64:79], v[44:47], v[48:51], v[64:79]
    v_mfma_f32_32x32x16_bf16 v[80:95], v[44:47], v[52:55], v[80:95]
    ds_read_b128 v[44:47], v12 offset:96
    ds_read_b64_tr_b16 v[48:49], v15 offset:6912
    ds_read_b64_tr_b16 v[50:51], v15 offset:7488
    ds_read_b64_tr_b16 v[52:53], v15 offset:6976
    ds_read_b64_tr_b16 v[54:55], v15 offset:7552
    s_waitcnt lgkmcnt(5)
    v_mfma_f32_32x32x16_bf16 v[64:79], v[32:35], v[36:39], v[64:79]
    v_mfma_f32_32x32x16_bf16 v[80:95], v[32:35], v[40:43], v[80:95]
    ds_read_b128 v[32:35], v12 offset:128
    ds_read_b64_tr_b16 v[36:37], v15 offset:9216
    ds_read_b64_tr_b16 v[38:39], v15 offset:9792
    ds_read_b64_tr_b16 v[40:41], v15 offset:9280
    ds_read_b64_tr_b16 v[42:43], v15 offset:9856
    s_waitcnt lgkmcnt(5)
    v_mfma_f32_32x32x16_bf16 v[64:79], v[44:47], v[48:51], v[64:79]
    v_mfma_f32_32x32x16_bf16 v[80:95], v[44:47], v[52:55], v[80:95]
    ds_read_b128 v[44:47], v12 offset:160
    ds_read_b64_tr_b16 v[48:49], v15 offset:11520
    ds_read_b64_tr_b16 v[50:51], v15 offset:12096
    ds_read_b64_tr_b16 v[52:53], v15 offset:11584
    ds_read_b64_tr_b16 v[54:55], v15 offset:12160
    s_waitcnt lgkmcnt(5)
    v_mfma_f32_32x32x16_bf16 v[64:79], v[32:35], v[36:39], v[64:79]
    v_mfma_f32_32x32x16_bf16 v[80:95], v[32:35], v[40:43], v[80:95]
    ds_read_b128 v[32:35], v12 offset:192
    ds_read_b64_tr_b16 v[36:37], v15 offset:13824
    ds_read_b64_tr_b16 v[38:39], v15 offset:14400
    ds_read_b64_tr_b16 v[40:41], v15 offset:13888
    ds_read_b64_tr_b16 v[42:43], v15 offset:14464
    s_waitcnt lgkmcnt(5)
    v_mfma_f32_32x32x16_bf16 v[64:79], v[44:47], v[48:51], v[64:79]
    v_mfma_f32_32x32x16_bf16 v[80:95], v[44:47], v[52:55], v[80:95]
    ds_read_b128 v[44:47], v12 offset:224
    ds_read_b64_tr_b16 v[48:49], v15 offset:16128
    ds_read_b64_tr_b16 v[50:51], v15 offset:16704
    ds_read_b64_tr_b16 v[52:53], v15 offset:16192
    ds_read_b64_tr_b16 v[54:55], v15 offset:16768
    s_waitcnt lgkmcnt(5)
    v_mfma_f32_32x32x16_bf16 v[64:79], v[32:35], v[36:39], v[64:79]
    v_mfma_f32_32x32x16_bf16 v[80:95], v[32:35], v[40:43], v[80:95]
    s_waitcnt lgkmcnt(0)
    v_mfma_f32_32x32x16_bf16 v[64:79], v[44:47], v[48:51], v[64:79]
    v_mfma_f32_32x32x16_bf16 v[80:95], v[44:47], v[52:55], v[80:95]
    s_barrier
    s_waitcnt vmcnt(11)
    ds_write_b128 v7, v[96:99] offset:0
    s_waitcnt vmcnt(10)
    ds_write_b128 v7, v[100:103] offset:4352
    s_waitcnt vmcnt(9)
    ds_write_b128 v7, v[104:107] offset:8704
    s_waitcnt vmcnt(8)
    ds_write_b128 v7, v[108:111] offset:13056
    s_waitcnt vmcnt(7)
    ds_write_b128 v7, v[112:115] offset:17408
    s_waitcnt vmcnt(6)
    ds_write_b128 v7, v[116:119] offset:21760
    s_waitcnt vmcnt(5)
    ds_write_b128 v7, v[120:123] offset:26112
    s_waitcnt vmcnt(4)
    ds_write_b128 v7, v[124:127] offset:30464
    s_waitcnt vmcnt(3)
    ds_write_b128 v18, v[128:131] offset:0
    s_waitcnt vmcnt(2)
    ds_write_b128 v18, v[132:135] offset:4608
    s_waitcnt vmcnt(1)
    ds_write_b128 v18, v[136:139] offset:9216
    s_waitcnt vmcnt(0)
    ds_write_b128 v18, v[140:143] offset:13824
    s_waitcnt lgkmcnt(0)
    s_barrier
    s_add_u32 s40, s39, 768
    buffer_load_dwordx4 v[96:99], v5, s[28:31], s40 offen
    s_add_u32 s40, s39, 17152
    buffer_load_dwordx4 v[100:103], v5, s[28:31], s40 offen
    s_add_u32 s40, s39, 33536
    buffer_load_dwordx4 v[104:107], v5, s[28:31], s40 offen
    s_add_u32 s40, s39, 49920
    buffer_load_dwordx4 v[108:111], v5, s[28:31], s40 offen
    s_add_u32 s40, s39, 66304
    buffer_load_dwordx4 v[112:115], v5, s[28:31], s40 offen
    s_add_u32 s40, s39, 82688
    buffer_load_dwordx4 v[116:119], v5, s[28:31], s40 offen
    s_add_u32 s40, s39, 99072
    buffer_load_dwordx4 v[120:123], v5, s[28:31], s40 offen
    s_add_u32 s40, s39, 115456
    buffer_load_dwordx4 v[124:127], v5, s[28:31], s40 offen
    s_add_u32 s40, s38, 1179648
    buffer_load_dwordx4 v[128:131], v6, s[32:35], s40 offen
    s_add_u32 s40, s38, 1277952
    buffer_load_dwordx4 v[132:135], v6, s[32:35], s40 offen
    s_add_u32 s40, s38, 1376256
    buffer_load_dwordx4 v[136:139], v6, s[32:35], s40 offen
    s_add_u32 s40, s38, 1474560
    buffer_load_dwordx4 v[140:143], v6, s[32:35], s40 offen
    ds_read_b128 v[32:35], v12 offset:0
    ds_read_b64_tr_b16 v[36:37], v15 offset:0
    ds_read_b64_tr_b16 v[38:39], v15 offset:576
    ds_read_b64_tr_b16 v[40:41], v15 offset:64
    ds_read_b64_tr_b16 v[42:43], v15 offset:640
    ds_read_b128 v[44:47], v12 offset:32
    ds_read_b64_tr_b16 v[48:49], v15 offset:2304
    ds_read_b64_tr_b16 v[50:51], v15 offset:2880
    ds_read_b64_tr_b16 v[52:53], v15 offset:2368
    ds_read_b64_tr_b16 v[54:55], v15 offset:2944
    s_waitcnt lgkmcnt(5)
    v_mfma_f32_32x32x16_bf16 v[64:79], v[32:35], v[36:39], v[64:79]
    v_mfma_f32_32x32x16_bf16 v[80:95], v[32:35], v[40:43], v[80:95]
    ds_read_b128 v[32:35], v12 offset:64
    ds_read_b64_tr_b16 v[36:37], v15 offset:4608
    ds_read_b64_tr_b16 v[38:39], v15 offset:5184
    ds_read_b64_tr_b16 v[40:41], v15 offset:4672
    ds_read_b64_tr_b16 v[42:43], v15 offset:5248
    s_waitcnt lgkmcnt(5)
    v_mfma_f32_32x32x16_bf16 v[64:79], v[44:47], v[48:51], v[64:79]
    v_mfma_f32_32x32x16_bf16 v[80:95], v[44:47], v[52:55], v[80:95]
    ds_read_b128 v[44:47], v12 offset:96
    ds_read_b64_tr_b16 v[48:49], v15 offset:6912
    ds_read_b64_tr_b16 v[50:51], v15 offset:7488
    ds_read_b64_tr_b16 v[52:53], v15 offset:6976
    ds_read_b64_tr_b16 v[54:55], v15 offset:7552
    s_waitcnt lgkmcnt(5)
    v_mfma_f32_32x32x16_bf16 v[64:79], v[32:35], v[36:39], v[64:79]
    v_mfma_f32_32x32x16_bf16 v[80:95], v[32:35], v[40:43], v[80:95]
    ds_read_b128 v[32:35], v12 offset:128
    ds_read_b64_tr_b16 v[36:37], v15 offset:9216
    ds_read_b64_tr_b16 v[38:39], v15 offset:9792
    ds_read_b64_tr_b16 v[40:41], v15 offset:9280
    ds_read_b64_tr_b16 v[42:43], v15 offset:9856
    s_waitcnt lgkmcnt(5)
    v_mfma_f32_32x32x16_bf16 v[64:79], v[44:47], v[48:51], v[64:79]
    v_mfma_f32_32x32x16_bf16 v[80:95], v[44:47], v[52:55], v[80:95]
    ds_read_b128 v[44:47], v12 offset:160
    ds_read_b64_tr_b16 v[48:49], v15 offset:11520
    ds_read_b64_tr_b16 v[50:51], v15 offset:12096
    ds_read_b64_tr_b16 v[52:53], v15 offset:11584
    ds_read_b64_tr_b16 v[54:55], v15 offset:12160
    s_waitcnt lgkmcnt(5)
    v_mfma_f32_32x32x16_bf16 v[64:79], v[32:35], v[36:39], v[64:79]
    v_mfma_f32_32x32x16_bf16 v[80:95], v[32:35], v[40:43], v[80:95]
    ds_read_b128 v[32:35], v12 offset:192
    ds_read_b64_tr_b16 v[36:37], v15 offset:13824
    ds_read_b64_tr_b16 v[38:39], v15 offset:14400
    ds_read_b64_tr_b16 v[40:41], v15 offset:13888
    ds_read_b64_tr_b16 v[42:43], v15 offset:14464
    s_waitcnt lgkmcnt(5)
    v_mfma_f32_32x32x16_bf16 v[64:79], v[44:47], v[48:51], v[64:79]
    v_mfma_f32_32x32x16_bf16 v[80:95], v[44:47], v[52:55], v[80:95]
    ds_read_b128 v[44:47], v12 offset:224
    ds_read_b64_tr_b16 v[48:49], v15 offset:16128
    ds_read_b64_tr_b16 v[50:51], v15 offset:16704
    ds_read_b64_tr_b16 v[52:53], v15 offset:16192
    ds_read_b64_tr_b16 v[54:55], v15 offset:16768
    s_waitcnt lgkmcnt(5)
    v_mfma_f32_32x32x16_bf16 v[64:79], v[32:35], v[36:39], v[64:79]
    v_mfma_f32_32x32x16_bf16 v[80:95], v[32:35], v[40:43], v[80:95]
    s_waitcnt lgkmcnt(0)
    v_mfma_f32_32x32x16_bf16 v[64:79], v[44:47], v[48:51], v[64:79]
    v_mfma_f32_32x32x16_bf16 v[80:95], v[44:47], v[52:55], v[80:95]
    s_barrier
    s_waitcnt vmcnt(11)
    ds_write_b128 v7, v[96:99] offset:0
    s_waitcnt vmcnt(10)
    ds_write_b128 v7, v[100:103] offset:4352
    s_waitcnt vmcnt(9)
    ds_write_b128 v7, v[104:107] offset:8704
    s_waitcnt vmcnt(8)
    ds_write_b128 v7, v[108:111] offset:13056
    s_waitcnt vmcnt(7)
    ds_write_b128 v7, v[112:115] offset:17408
    s_waitcnt vmcnt(6)
    ds_write_b128 v7, v[116:119] offset:21760
    s_waitcnt vmcnt(5)
    ds_write_b128 v7, v[120:123] offset:26112
    s_waitcnt vmcnt(4)
    ds_write_b128 v7, v[124:127] offset:30464
    s_waitcnt vmcnt(3)
    ds_write_b128 v18, v[128:131] offset:0
    s_waitcnt vmcnt(2)
    ds_write_b128 v18, v[132:135] offset:4608
    s_waitcnt vmcnt(1)
    ds_write_b128 v18, v[136:139] offset:9216
    s_waitcnt vmcnt(0)
    ds_write_b128 v18, v[140:143] offset:13824
    s_waitcnt lgkmcnt(0)
    s_barrier
    ds_read_b128 v[32:35], v12 offset:0
    ds_read_b64_tr_b16 v[36:37], v15 offset:0
    ds_read_b64_tr_b16 v[38:39], v15 offset:576
    ds_read_b64_tr_b16 v[40:41], v15 offset:64
    ds_read_b64_tr_b16 v[42:43], v15 offset:640
    ds_read_b128 v[44:47], v12 offset:32
    ds_read_b64_tr_b16 v[48:49], v15 offset:2304
    ds_read_b64_tr_b16 v[50:51], v15 offset:2880
    ds_read_b64_tr_b16 v[52:53], v15 offset:2368
    ds_read_b64_tr_b16 v[54:55], v15 offset:2944
    s_waitcnt lgkmcnt(5)
    v_mfma_f32_32x32x16_bf16 v[64:79], v[32:35], v[36:39], v[64:79]
    v_mfma_f32_32x32x16_bf16 v[80:95], v[32:35], v[40:43], v[80:95]
    ds_read_b128 v[32:35], v12 offset:64
    ds_read_b64_tr_b16 v[36:37], v15 offset:4608
    ds_read_b64_tr_b16 v[38:39], v15 offset:5184
    ds_read_b64_tr_b16 v[40:41], v15 offset:4672
    ds_read_b64_tr_b16 v[42:43], v15 offset:5248
    s_waitcnt lgkmcnt(5)
    v_mfma_f32_32x32x16_bf16 v[64:79], v[44:47], v[48:51], v[64:79]
    v_mfma_f32_32x32x16_bf16 v[80:95], v[44:47], v[52:55], v[80:95]
    ds_read_b128 v[44:47], v12 offset:96
    ds_read_b64_tr_b16 v[48:49], v15 offset:6912
    ds_read_b64_tr_b16 v[50:51], v15 offset:7488
    ds_read_b64_tr_b16 v[52:53], v15 offset:6976
    ds_read_b64_tr_b16 v[54:55], v15 offset:7552
    s_waitcnt lgkmcnt(5)
    v_mfma_f32_32x32x16_bf16 v[64:79], v[32:35], v[36:39], v[64:79]
    v_mfma_f32_32x32x16_bf16 v[80:95], v[32:35], v[40:43], v[80:95]
    ds_read_b128 v[32:35], v12 offset:128
    ds_read_b64_tr_b16 v[36:37], v15 offset:9216
    ds_read_b64_tr_b16 v[38:39], v15 offset:9792
    ds_read_b64_tr_b16 v[40:41], v15 offset:9280
    ds_read_b64_tr_b16 v[42:43], v15 offset:9856
    s_waitcnt lgkmcnt(5)
    v_mfma_f32_32x32x16_bf16 v[64:79], v[44:47], v[48:51], v[64:79]
    v_mfma_f32_32x32x16_bf16 v[80:95], v[44:47], v[52:55], v[80:95]
    ds_read_b128 v[44:47], v12 offset:160
    ds_read_b64_tr_b16 v[48:49], v15 offset:11520
    ds_read_b64_tr_b16 v[50:51], v15 offset:12096
    ds_read_b64_tr_b16 v[52:53], v15 offset:11584
    ds_read_b64_tr_b16 v[54:55], v15 offset:12160
    s_waitcnt lgkmcnt(5)
    v_mfma_f32_32x32x16_bf16 v[64:79], v[32:35], v[36:39], v[64:79]
    v_mfma_f32_32x32x16_bf16 v[80:95], v[32:35], v[40:43], v[80:95]
    ds_read_b128 v[32:35], v12 offset:192
    ds_read_b64_tr_b16 v[36:37], v15 offset:13824
    ds_read_b64_tr_b16 v[38:39], v15 offset:14400
    ds_read_b64_tr_b16 v[40:41], v15 offset:13888
    ds_read_b64_tr_b16 v[42:43], v15 offset:14464
    s_waitcnt lgkmcnt(5)
    v_mfma_f32_32x32x16_bf16 v[64:79], v[44:47], v[48:51], v[64:79]
    v_mfma_f32_32x32x16_bf16 v[80:95], v[44:47], v[52:55], v[80:95]
    ds_read_b128 v[44:47], v12 offset:224
    ds_read_b64_tr_b16 v[48:49], v15 offset:16128
    ds_read_b64_tr_b16 v[50:51], v15 offset:16704
    ds_read_b64_tr_b16 v[52:53], v15 offset:16192
    ds_read_b64_tr_b16 v[54:55], v15 offset:16768
    s_waitcnt lgkmcnt(5)
    v_mfma_f32_32x32x16_bf16 v[64:79], v[32:35], v[36:39], v[64:79]
    v_mfma_f32_32x32x16_bf16 v[80:95], v[32:35], v[40:43], v[80:95]
    s_waitcnt lgkmcnt(0)
    v_mfma_f32_32x32x16_bf16 v[64:79], v[44:47], v[48:51], v[64:79]
    v_mfma_f32_32x32x16_bf16 v[80:95], v[44:47], v[52:55], v[80:95]
    s_nop 7
    s_nop 7
    s_sub_u32 s42, s37, 16
    s_lshl_b32 s42, s42, 18
    s_add_u32 s42, s42, 4194304
    s_lshl_b32 s43, s36, 12
    s_add_u32 s42, s42, s43
    v_lshrrev_b32 v12, 4, v8
    v_lshlrev_b32 v12, 16, v12
    v_and_b32 v13, 15, v8
    v_lshl_add_u32 v12, v13, 6, v12
    v_lshl_add_u32 v12, v9, 3, v12
    v_lshl_add_u32 v12, v2, 10, v12
    v_add_u32 v12, s42, v12
    v_cvt_pk_bf16_f32 v48, v64, v65
    v_cvt_pk_bf16_f32 v49, v66, v67
    s_mov_b32 s43, 0
    buffer_store_dwordx2 v[48:49], v12, s[24:27], s43 offen offset:0
    v_cvt_pk_bf16_f32 v50, v68, v69
    v_cvt_pk_bf16_f32 v51, v70, v71
    s_mov_b32 s43, 0
    buffer_store_dwordx2 v[50:51], v12, s[24:27], s43 offen offset:16
    v_cvt_pk_bf16_f32 v48, v72, v73
    v_cvt_pk_bf16_f32 v49, v74, v75
    s_mov_b32 s43, 0
    buffer_store_dwordx2 v[48:49], v12, s[24:27], s43 offen offset:32
    v_cvt_pk_bf16_f32 v50, v76, v77
    v_cvt_pk_bf16_f32 v51, v78, v79
    s_mov_b32 s43, 0
    buffer_store_dwordx2 v[50:51], v12, s[24:27], s43 offen offset:48
    v_cvt_pk_bf16_f32 v48, v80, v81
    v_cvt_pk_bf16_f32 v49, v82, v83
    s_mov_b32 s43, 131072
    buffer_store_dwordx2 v[48:49], v12, s[24:27], s43 offen offset:0
    v_cvt_pk_bf16_f32 v50, v84, v85
    v_cvt_pk_bf16_f32 v51, v86, v87
    s_mov_b32 s43, 131072
    buffer_store_dwordx2 v[50:51], v12, s[24:27], s43 offen offset:16
    v_cvt_pk_bf16_f32 v48, v88, v89
    v_cvt_pk_bf16_f32 v49, v90, v91
    s_mov_b32 s43, 131072
    buffer_store_dwordx2 v[48:49], v12, s[24:27], s43 offen offset:32
    v_cvt_pk_bf16_f32 v50, v92, v93
    v_cvt_pk_bf16_f32 v51, v94, v95
    s_mov_b32 s43, 131072
    buffer_store_dwordx2 v[50:51], v12, s[24:27], s43 offen offset:48
K1_END:
    s_endpgm
.globl k2_kernel
.p2align 8
.type k2_kernel,@function
k2_kernel:
    s_cmp_ge_u32 s2, 768
    s_cbranch_scc1 K2_END
    s_load_dwordx2 s[12:13], s[0:1], 96
    s_load_dwordx4 s[16:19], s[0:1], 32
    v_and_b32 v1, 63, v0
    v_lshrrev_b32 v2, 6, v0
    s_nop 1
    v_readfirstlane_b32 s32, v2
    s_waitcnt lgkmcnt(0)
    s_mov_b32 s28, s12
    s_and_b32 s29, s13, 0xffff
    s_mov_b32 s30, 268435456
    s_mov_b32 s31, 0x00020000
    s_cmp_lt_u32 s2, 256
    s_cbranch_scc1 K2_CONV
    s_sub_u32 s6, s2, 256
    s_lshr_b32 s4, s6, 3
    s_and_b32 s5, s6, 7
    s_lshl_b32 s3, s4, 5
    s_lshl_b32 s36, s5, 2
    s_add_u32 s36, s36, s32
    v_and_b32 v8, 31, v1
    v_lshrrev_b32 v9, 5, v1
    v_xor_b32 v10, 32, v1
    v_lshlrev_b32 v10, 2, v10
    s_sub_u32 s35, 8, s4
    s_max_i32 s35, s35, 0
    s_lshl_b32 s38, s36, 16
    s_lshl_b32 s39, s3, 5
    s_add_u32 s39, s39, s38
    v_lshlrev_b32 v11, 5, v8
    v_lshl_add_u32 v11, v9, 4, v11
    v_add_u32 v11, s39, v11
    buffer_load_dwordx4 v[16:19], v11, s[28:31], 0 offen
    v_add_u32 v12, 2088960, v11
    v_and_b32 v13, 15, v1
    v_lshlrev_b32 v13, 6, v13
    v_lshl_add_u32 v13, v9, 3, v13
    s_add_u32 s39, s39, 4186112
    v_add_u32 v13, s39, v13
    s_cmp_lt_i32 s35, 1
    s_cbranch_scc0 K2_L0
    s_mov_b32 s40, 0
    buffer_load_dwordx4 v[92:95], v12, s[28:31], s40 offen
K2_L0:
    s_cmp_lt_i32 s35, 2
    s_cbranch_scc0 K2_L1
    s_mov_b32 s40, 1024
    buffer_load_dwordx4 v[96:99], v12, s[28:31], s40 offen
K2_L1:
    s_cmp_lt_i32 s35, 3
    s_cbranch_scc0 K2_L2
    s_mov_b32 s40, 2048
    buffer_load_dwordx4 v[100:103], v12, s[28:31], s40 offen
K2_L2:
    s_cmp_lt_i32 s35, 4
    s_cbranch_scc0 K2_L3
    s_mov_b32 s40, 3072
    buffer_load_dwordx4 v[104:107], v12, s[28:31], s40 offen
K2_L3:
    s_cmp_lt_i32 s35, 5
    s_cbranch_scc0 K2_L4
    s_mov_b32 s40, 4096
    buffer_load_dwordx4 v[108:111], v12, s[28:31], s40 offen
K2_L4:
    s_cmp_lt_i32 s35, 6
    s_cbranch_scc0 K2_L5
    s_mov_b32 s40, 5120
    buffer_load_dwordx4 v[112:115], v12, s[28:31], s40 offen
K2_L5:
    s_cmp_lt_i32 s35, 7
    s_cbranch_scc0 K2_L6
    s_mov_b32 s40, 6144
    buffer_load_dwordx4 v[116:119], v12, s[28:31], s40 offen
K2_L6:
    s_cmp_lt_i32 s35, 8
    s_cbranch_scc0 K2_L7
    s_mov_b32 s40, 7168
    buffer_load_dwordx4 v[120:123], v12, s[28:31], s40 offen
K2_L7:
    s_cmp_lt_i32 s35, 9
    s_cbranch_scc0 K2_L8
    s_mov_b32 s40, 8192
    buffer_load_dwordx4 v[124:127], v12, s[28:31], s40 offen
K2_L8:
    v_lshlrev_b32 v14, 2, v9
    v_mov_b32 v15, 0xf149f2ca
    v_mov_b32 v3, v15
    s_cmp_lt_i32 s35, 1
    s_cbranch_scc0 K2_SK0
    v_mov_b32 v128, 0
    v_mov_b32 v129, 0
    v_mov_b32 v130, 0
    v_mov_b32 v131, 0
    v_mov_b32 v132, 0
    v_mov_b32 v133, 0
    v_mov_b32 v134, 0
    v_mov_b32 v135, 0
    v_mov_b32 v136, 0
    v_mov_b32 v137, 0
    v_mov_b32 v138, 0
    v_mov_b32 v139, 0
    v_mov_b32 v140, 0
    v_mov_b32 v141, 0
    v_mov_b32 v142, 0
    v_mov_b32 v143, 0
    s_waitcnt vmcnt(8)
    s_nop 1
    v_mfma_f32_32x32x16_bf16 v[128:143], v[92:95], v[16:19], v[128:143]
    s_nop 7
    s_nop 4
    v_add_u32 v4, 0, v14
    v_cmp_gt_u32 vcc, v4, v8
    s_nop 1
    v_cndmask_b32 v128, v15, v128, vcc
    v_add_u32 v4, 1, v14
    v_cmp_gt_u32 vcc, v4, v8
    s_nop 1
    v_cndmask_b32 v129, v15, v129, vcc
    v_add_u32 v4, 2, v14
    v_cmp_gt_u32 vcc, v4, v8
    s_nop 1
    v_cndmask_b32 v130, v15, v130, vcc
    v_add_u32 v4, 3, v14
    v_cmp_gt_u32 vcc, v4, v8
    s_nop 1
    v_cndmask_b32 v131, v15, v131, vcc
    v_add_u32 v4, 8, v14
    v_cmp_gt_u32 vcc, v4, v8
    s_nop 1
    v_cndmask_b32 v132, v15, v132, vcc
    v_add_u32 v4, 9, v14
    v_cmp_gt_u32 vcc, v4, v8
    s_nop 1
    v_cndmask_b32 v133, v15, v133, vcc
    v_add_u32 v4, 10, v14
    v_cmp_gt_u32 vcc, v4, v8
    s_nop 1
    v_cndmask_b32 v134, v15, v134, vcc
    v_add_u32 v4, 11, v14
    v_cmp_gt_u32 vcc, v4, v8
    s_nop 1
    v_cndmask_b32 v135, v15, v135, vcc
    v_add_u32 v4, 16, v14
    v_cmp_gt_u32 vcc, v4, v8
    s_nop 1
    v_cndmask_b32 v136, v15, v136, vcc
    v_add_u32 v4, 17, v14
    v_cmp_gt_u32 vcc, v4, v8
    s_nop 1
    v_cndmask_b32 v137, v15, v137, vcc
    v_add_u32 v4, 18, v14
    v_cmp_gt_u32 vcc, v4, v8
    s_nop 1
    v_cndmask_b32 v138, v15, v138, vcc
    v_add_u32 v4, 19, v14
    v_cmp_gt_u32 vcc, v4, v8
    s_nop 1
    v_cndmask_b32 v139, v15, v139, vcc
    v_add_u32 v4, 24, v14
    v_cmp_gt_u32 vcc, v4, v8
    s_nop 1
    v_cndmask_b32 v140, v15, v140, vcc
    v_add_u32 v4, 25, v14
    v_cmp_gt_u32 vcc, v4, v8
    s_nop 1
    v_cndmask_b32 v141, v15, v141, vcc
    v_add_u32 v4, 26, v14
    v_cmp_gt_u32 vcc, v4, v8
    s_nop 1
    v_cndmask_b32 v142, v15, v142, vcc
    v_add_u32 v4, 27, v14
    v_cmp_gt_u32 vcc, v4, v8
    s_nop 1
    v_cndmask_b32 v143, v15, v143, vcc
    v_cvt_pk_bf16_f32 v20, v128, v129
    v_max3_f32 v3, v3, v128, v129
    v_cvt_pk_bf16_f32 v21, v130, v131
    v_max3_f32 v3, v3, v130, v131
    v_cvt_pk_bf16_f32 v22, v132, v133
    v_max3_f32 v3, v3, v132, v133
    v_cvt_pk_bf16_f32 v23, v134, v135
    v_max3_f32 v3, v3, v134, v135
    v_cvt_pk_bf16_f32 v24, v136, v137
    v_max3_f32 v3, v3, v136, v137
    v_cvt_pk_bf16_f32 v25, v138, v139
    v_max3_f32 v3, v3, v138, v139
    v_cvt_pk_bf16_f32 v26, v140, v141
    v_max3_f32 v3, v3, v140, v141
    v_cvt_pk_bf16_f32 v27, v142, v143
    v_max3_f32 v3, v3, v142, v143
    s_branch K2_DN0
K2_SK0:
    v_mov_b32 v20, 0xf149f149
    v_mov_b32 v21, 0xf149f149
    v_mov_b32 v22, 0xf149f149
    v_mov_b32 v23, 0xf149f149
    v_mov_b32 v24, 0xf149f149
    v_mov_b32 v25, 0xf149f149
    v_mov_b32 v26, 0xf149f149
    v_mov_b32 v27, 0xf149f149
K2_DN0:
    s_cmp_lt_i32 s35, 2
    s_cbranch_scc0 K2_SK1
    v_mov_b32 v128, 0
    v_mov_b32 v129, 0
    v_mov_b32 v130, 0
    v_mov_b32 v131, 0
    v_mov_b32 v132, 0
    v_mov_b32 v133, 0
    v_mov_b32 v134, 0
    v_mov_b32 v135, 0
    v_mov_b32 v136, 0
    v_mov_b32 v137, 0
    v_mov_b32 v138, 0
    v_mov_b32 v139, 0
    v_mov_b32 v140, 0
    v_mov_b32 v141, 0
    v_mov_b32 v142, 0
    v_mov_b32 v143, 0
    s_waitcnt vmcnt(7)
    s_nop 1
    v_mfma_f32_32x32x16_bf16 v[128:143], v[96:99], v[16:19], v[128:143]
    s_nop 7
    s_nop 4
    v_cvt_pk_bf16_f32 v28, v128, v129
    v_max3_f32 v3, v3, v128, v129
    v_cvt_pk_bf16_f32 v29, v130, v131
    v_max3_f32 v3, v3, v130, v131
    v_cvt_pk_bf16_f32 v30, v132, v133
    v_max3_f32 v3, v3, v132, v133
    v_cvt_pk_bf16_f32 v31, v134, v135
    v_max3_f32 v3, v3, v134, v135
    v_cvt_pk_bf16_f32 v32, v136, v137
    v_max3_f32 v3, v3, v136, v137
    v_cvt_pk_bf16_f32 v33, v138, v139
    v_max3_f32 v3, v3, v138, v139
    v_cvt_pk_bf16_f32 v34, v140, v141
    v_max3_f32 v3, v3, v140, v141
    v_cvt_pk_bf16_f32 v35, v142, v143
    v_max3_f32 v3, v3, v142, v143
    s_branch K2_DN1
K2_SK1:
    v_mov_b32 v28, 0xf149f149
    v_mov_b32 v29, 0xf149f149
    v_mov_b32 v30, 0xf149f149
    v_mov_b32 v31, 0xf149f149
    v_mov_b32 v32, 0xf149f149
    v_mov_b32 v33, 0xf149f149
    v_mov_b32 v34, 0xf149f149
    v_mov_b32 v35, 0xf149f149
K2_DN1:
    s_cmp_lt_i32 s35, 3
    s_cbranch_scc0 K2_SK2
    v_mov_b32 v128, 0
    v_mov_b32 v129, 0
    v_mov_b32 v130, 0
    v_mov_b32 v131, 0
    v_mov_b32 v132, 0
    v_mov_b32 v133, 0
    v_mov_b32 v134, 0
    v_mov_b32 v135, 0
    v_mov_b32 v136, 0
    v_mov_b32 v137, 0
    v_mov_b32 v138, 0
    v_mov_b32 v139, 0
    v_mov_b32 v140, 0
    v_mov_b32 v141, 0
    v_mov_b32 v142, 0
    v_mov_b32 v143, 0
    s_waitcnt vmcnt(6)
    s_nop 1
    v_mfma_f32_32x32x16_bf16 v[128:143], v[100:103], v[16:19], v[128:143]
    s_nop 7
    s_nop 4
    v_cvt_pk_bf16_f32 v36, v128, v129
    v_max3_f32 v3, v3, v128, v129
    v_cvt_pk_bf16_f32 v37, v130, v131
    v_max3_f32 v3, v3, v130, v131
    v_cvt_pk_bf16_f32 v38, v132, v133
    v_max3_f32 v3, v3, v132, v133
    v_cvt_pk_bf16_f32 v39, v134, v135
    v_max3_f32 v3, v3, v134, v135
    v_cvt_pk_bf16_f32 v40, v136, v137
    v_max3_f32 v3, v3, v136, v137
    v_cvt_pk_bf16_f32 v41, v138, v139
    v_max3_f32 v3, v3, v138, v139
    v_cvt_pk_bf16_f32 v42, v140, v141
    v_max3_f32 v3, v3, v140, v141
    v_cvt_pk_bf16_f32 v43, v142, v143
    v_max3_f32 v3, v3, v142, v143
    s_branch K2_DN2
K2_SK2:
    v_mov_b32 v36, 0xf149f149
    v_mov_b32 v37, 0xf149f149
    v_mov_b32 v38, 0xf149f149
    v_mov_b32 v39, 0xf149f149
    v_mov_b32 v40, 0xf149f149
    v_mov_b32 v41, 0xf149f149
    v_mov_b32 v42, 0xf149f149
    v_mov_b32 v43, 0xf149f149
K2_DN2:
    s_cmp_lt_i32 s35, 4
    s_cbranch_scc0 K2_SK3
    v_mov_b32 v128, 0
    v_mov_b32 v129, 0
    v_mov_b32 v130, 0
    v_mov_b32 v131, 0
    v_mov_b32 v132, 0
    v_mov_b32 v133, 0
    v_mov_b32 v134, 0
    v_mov_b32 v135, 0
    v_mov_b32 v136, 0
    v_mov_b32 v137, 0
    v_mov_b32 v138, 0
    v_mov_b32 v139, 0
    v_mov_b32 v140, 0
    v_mov_b32 v141, 0
    v_mov_b32 v142, 0
    v_mov_b32 v143, 0
    s_waitcnt vmcnt(5)
    s_nop 1
    v_mfma_f32_32x32x16_bf16 v[128:143], v[104:107], v[16:19], v[128:143]
    s_nop 7
    s_nop 4
    v_cvt_pk_bf16_f32 v44, v128, v129
    v_max3_f32 v3, v3, v128, v129
    v_cvt_pk_bf16_f32 v45, v130, v131
    v_max3_f32 v3, v3, v130, v131
    v_cvt_pk_bf16_f32 v46, v132, v133
    v_max3_f32 v3, v3, v132, v133
    v_cvt_pk_bf16_f32 v47, v134, v135
    v_max3_f32 v3, v3, v134, v135
    v_cvt_pk_bf16_f32 v48, v136, v137
    v_max3_f32 v3, v3, v136, v137
    v_cvt_pk_bf16_f32 v49, v138, v139
    v_max3_f32 v3, v3, v138, v139
    v_cvt_pk_bf16_f32 v50, v140, v141
    v_max3_f32 v3, v3, v140, v141
    v_cvt_pk_bf16_f32 v51, v142, v143
    v_max3_f32 v3, v3, v142, v143
    s_branch K2_DN3
K2_SK3:
    v_mov_b32 v44, 0xf149f149
    v_mov_b32 v45, 0xf149f149
    v_mov_b32 v46, 0xf149f149
    v_mov_b32 v47, 0xf149f149
    v_mov_b32 v48, 0xf149f149
    v_mov_b32 v49, 0xf149f149
    v_mov_b32 v50, 0xf149f149
    v_mov_b32 v51, 0xf149f149
K2_DN3:
    s_cmp_lt_i32 s35, 5
    s_cbranch_scc0 K2_SK4
    v_mov_b32 v128, 0
    v_mov_b32 v129, 0
    v_mov_b32 v130, 0
    v_mov_b32 v131, 0
    v_mov_b32 v132, 0
    v_mov_b32 v133, 0
    v_mov_b32 v134, 0
    v_mov_b32 v135, 0
    v_mov_b32 v136, 0
    v_mov_b32 v137, 0
    v_mov_b32 v138, 0
    v_mov_b32 v139, 0
    v_mov_b32 v140, 0
    v_mov_b32 v141, 0
    v_mov_b32 v142, 0
    v_mov_b32 v143, 0
    s_waitcnt vmcnt(4)
    s_nop 1
    v_mfma_f32_32x32x16_bf16 v[128:143], v[108:111], v[16:19], v[128:143]
    s_nop 7
    s_nop 4
    v_cvt_pk_bf16_f32 v52, v128, v129
    v_max3_f32 v3, v3, v128, v129
    v_cvt_pk_bf16_f32 v53, v130, v131
    v_max3_f32 v3, v3, v130, v131
    v_cvt_pk_bf16_f32 v54, v132, v133
    v_max3_f32 v3, v3, v132, v133
    v_cvt_pk_bf16_f32 v55, v134, v135
    v_max3_f32 v3, v3, v134, v135
    v_cvt_pk_bf16_f32 v56, v136, v137
    v_max3_f32 v3, v3, v136, v137
    v_cvt_pk_bf16_f32 v57, v138, v139
    v_max3_f32 v3, v3, v138, v139
    v_cvt_pk_bf16_f32 v58, v140, v141
    v_max3_f32 v3, v3, v140, v141
    v_cvt_pk_bf16_f32 v59, v142, v143
    v_max3_f32 v3, v3, v142, v143
    s_branch K2_DN4
K2_SK4:
    v_mov_b32 v52, 0xf149f149
    v_mov_b32 v53, 0xf149f149
    v_mov_b32 v54, 0xf149f149
    v_mov_b32 v55, 0xf149f149
    v_mov_b32 v56, 0xf149f149
    v_mov_b32 v57, 0xf149f149
    v_mov_b32 v58, 0xf149f149
    v_mov_b32 v59, 0xf149f149
K2_DN4:
    s_cmp_lt_i32 s35, 6
    s_cbranch_scc0 K2_SK5
    v_mov_b32 v128, 0
    v_mov_b32 v129, 0
    v_mov_b32 v130, 0
    v_mov_b32 v131, 0
    v_mov_b32 v132, 0
    v_mov_b32 v133, 0
    v_mov_b32 v134, 0
    v_mov_b32 v135, 0
    v_mov_b32 v136, 0
    v_mov_b32 v137, 0
    v_mov_b32 v138, 0
    v_mov_b32 v139, 0
    v_mov_b32 v140, 0
    v_mov_b32 v141, 0
    v_mov_b32 v142, 0
    v_mov_b32 v143, 0
    s_waitcnt vmcnt(3)
    s_nop 1
    v_mfma_f32_32x32x16_bf16 v[128:143], v[112:115], v[16:19], v[128:143]
    s_nop 7
    s_nop 4
    v_cvt_pk_bf16_f32 v60, v128, v129
    v_max3_f32 v3, v3, v128, v129
    v_cvt_pk_bf16_f32 v61, v130, v131
    v_max3_f32 v3, v3, v130, v131
    v_cvt_pk_bf16_f32 v62, v132, v133
    v_max3_f32 v3, v3, v132, v133
    v_cvt_pk_bf16_f32 v63, v134, v135
    v_max3_f32 v3, v3, v134, v135
    v_cvt_pk_bf16_f32 v64, v136, v137
    v_max3_f32 v3, v3, v136, v137
    v_cvt_pk_bf16_f32 v65, v138, v139
    v_max3_f32 v3, v3, v138, v139
    v_cvt_pk_bf16_f32 v66, v140, v141
    v_max3_f32 v3, v3, v140, v141
    v_cvt_pk_bf16_f32 v67, v142, v143
    v_max3_f32 v3, v3, v142, v143
    s_branch K2_DN5
K2_SK5:
    v_mov_b32 v60, 0xf149f149
    v_mov_b32 v61, 0xf149f149
    v_mov_b32 v62, 0xf149f149
    v_mov_b32 v63, 0xf149f149
    v_mov_b32 v64, 0xf149f149
    v_mov_b32 v65, 0xf149f149
    v_mov_b32 v66, 0xf149f149
    v_mov_b32 v67, 0xf149f149
K2_DN5:
    s_cmp_lt_i32 s35, 7
    s_cbranch_scc0 K2_SK6
    v_mov_b32 v128, 0
    v_mov_b32 v129, 0
    v_mov_b32 v130, 0
    v_mov_b32 v131, 0
    v_mov_b32 v132, 0
    v_mov_b32 v133, 0
    v_mov_b32 v134, 0
    v_mov_b32 v135, 0
    v_mov_b32 v136, 0
    v_mov_b32 v137, 0
    v_mov_b32 v138, 0
    v_mov_b32 v139, 0
    v_mov_b32 v140, 0
    v_mov_b32 v141, 0
    v_mov_b32 v142, 0
    v_mov_b32 v143, 0
    s_waitcnt vmcnt(2)
    s_nop 1
    v_mfma_f32_32x32x16_bf16 v[128:143], v[116:119], v[16:19], v[128:143]
    s_nop 7
    s_nop 4
    v_cvt_pk_bf16_f32 v68, v128, v129
    v_max3_f32 v3, v3, v128, v129
    v_cvt_pk_bf16_f32 v69, v130, v131
    v_max3_f32 v3, v3, v130, v131
    v_cvt_pk_bf16_f32 v70, v132, v133
    v_max3_f32 v3, v3, v132, v133
    v_cvt_pk_bf16_f32 v71, v134, v135
    v_max3_f32 v3, v3, v134, v135
    v_cvt_pk_bf16_f32 v72, v136, v137
    v_max3_f32 v3, v3, v136, v137
    v_cvt_pk_bf16_f32 v73, v138, v139
    v_max3_f32 v3, v3, v138, v139
    v_cvt_pk_bf16_f32 v74, v140, v141
    v_max3_f32 v3, v3, v140, v141
    v_cvt_pk_bf16_f32 v75, v142, v143
    v_max3_f32 v3, v3, v142, v143
    s_branch K2_DN6
K2_SK6:
    v_mov_b32 v68, 0xf149f149
    v_mov_b32 v69, 0xf149f149
    v_mov_b32 v70, 0xf149f149
    v_mov_b32 v71, 0xf149f149
    v_mov_b32 v72, 0xf149f149
    v_mov_b32 v73, 0xf149f149
    v_mov_b32 v74, 0xf149f149
    v_mov_b32 v75, 0xf149f149
K2_DN6:
    s_cmp_lt_i32 s35, 8
    s_cbranch_scc0 K2_SK7
    v_mov_b32 v128, 0
    v_mov_b32 v129, 0
    v_mov_b32 v130, 0
    v_mov_b32 v131, 0
    v_mov_b32 v132, 0
    v_mov_b32 v133, 0
    v_mov_b32 v134, 0
    v_mov_b32 v135, 0
    v_mov_b32 v136, 0
    v_mov_b32 v137, 0
    v_mov_b32 v138, 0
    v_mov_b32 v139, 0
    v_mov_b32 v140, 0
    v_mov_b32 v141, 0
    v_mov_b32 v142, 0
    v_mov_b32 v143, 0
    s_waitcnt vmcnt(1)
    s_nop 1
    v_mfma_f32_32x32x16_bf16 v[128:143], v[120:123], v[16:19], v[128:143]
    s_nop 7
    s_nop 4
    v_cvt_pk_bf16_f32 v76, v128, v129
    v_max3_f32 v3, v3, v128, v129
    v_cvt_pk_bf16_f32 v77, v130, v131
    v_max3_f32 v3, v3, v130, v131
    v_cvt_pk_bf16_f32 v78, v132, v133
    v_max3_f32 v3, v3, v132, v133
    v_cvt_pk_bf16_f32 v79, v134, v135
    v_max3_f32 v3, v3, v134, v135
    v_cvt_pk_bf16_f32 v80, v136, v137
    v_max3_f32 v3, v3, v136, v137
    v_cvt_pk_bf16_f32 v81, v138, v139
    v_max3_f32 v3, v3, v138, v139
    v_cvt_pk_bf16_f32 v82, v140, v141
    v_max3_f32 v3, v3, v140, v141
    v_cvt_pk_bf16_f32 v83, v142, v143
    v_max3_f32 v3, v3, v142, v143
    s_branch K2_DN7
K2_SK7:
    v_mov_b32 v76, 0xf149f149
    v_mov_b32 v77, 0xf149f149
    v_mov_b32 v78, 0xf149f149
    v_mov_b32 v79, 0xf149f149
    v_mov_b32 v80, 0xf149f149
    v_mov_b32 v81, 0xf149f149
    v_mov_b32 v82, 0xf149f149
    v_mov_b32 v83, 0xf149f149
K2_DN7:
    s_cmp_lt_i32 s35, 9
    s_cbranch_scc0 K2_SK8
    v_mov_b32 v128, 0
    v_mov_b32 v129, 0
    v_mov_b32 v130, 0
    v_mov_b32 v131, 0
    v_mov_b32 v132, 0
    v_mov_b32 v133, 0
    v_mov_b32 v134, 0
    v_mov_b32 v135, 0
    v_mov_b32 v136, 0
    v_mov_b32 v137, 0
    v_mov_b32 v138, 0
    v_mov_b32 v139, 0
    v_mov_b32 v140, 0
    v_mov_b32 v141, 0
    v_mov_b32 v142, 0
    v_mov_b32 v143, 0
    s_waitcnt vmcnt(0)
    s_nop 1
    v_mfma_f32_32x32x16_bf16 v[128:143], v[124:127], v[16:19], v[128:143]
    s_nop 7
    s_nop 4
    v_add_u32 v4, 0, v14
    v_cmp_le_u32 vcc, v4, v8
    s_nop 1
    v_cndmask_b32 v128, v15, v128, vcc
    v_add_u32 v4, 1, v14
    v_cmp_le_u32 vcc, v4, v8
    s_nop 1
    v_cndmask_b32 v129, v15, v129, vcc
    v_add_u32 v4, 2, v14
    v_cmp_le_u32 vcc, v4, v8
    s_nop 1
    v_cndmask_b32 v130, v15, v130, vcc
    v_add_u32 v4, 3, v14
    v_cmp_le_u32 vcc, v4, v8
    s_nop 1
    v_cndmask_b32 v131, v15, v131, vcc
    v_add_u32 v4, 8, v14
    v_cmp_le_u32 vcc, v4, v8
    s_nop 1
    v_cndmask_b32 v132, v15, v132, vcc
    v_add_u32 v4, 9, v14
    v_cmp_le_u32 vcc, v4, v8
    s_nop 1
    v_cndmask_b32 v133, v15, v133, vcc
    v_add_u32 v4, 10, v14
    v_cmp_le_u32 vcc, v4, v8
    s_nop 1
    v_cndmask_b32 v134, v15, v134, vcc
    v_add_u32 v4, 11, v14
    v_cmp_le_u32 vcc, v4, v8
    s_nop 1
    v_cndmask_b32 v135, v15, v135, vcc
    v_add_u32 v4, 16, v14
    v_cmp_le_u32 vcc, v4, v8
    s_nop 1
    v_cndmask_b32 v136, v15, v136, vcc
    v_add_u32 v4, 17, v14
    v_cmp_le_u32 vcc, v4, v8
    s_nop 1
    v_cndmask_b32 v137, v15, v137, vcc
    v_add_u32 v4, 18, v14
    v_cmp_le_u32 vcc, v4, v8
    s_nop 1
    v_cndmask_b32 v138, v15, v138, vcc
    v_add_u32 v4, 19, v14
    v_cmp_le_u32 vcc, v4, v8
    s_nop 1
    v_cndmask_b32 v139, v15, v139, vcc
    v_add_u32 v4, 24, v14
    v_cmp_le_u32 vcc, v4, v8
    s_nop 1
    v_cndmask_b32 v140, v15, v140, vcc
    v_add_u32 v4, 25, v14
    v_cmp_le_u32 vcc, v4, v8
    s_nop 1
    v_cndmask_b32 v141, v15, v141, vcc
    v_add_u32 v4, 26, v14
    v_cmp_le_u32 vcc, v4, v8
    s_nop 1
    v_cndmask_b32 v142, v15, v142, vcc
    v_add_u32 v4, 27, v14
    v_cmp_le_u32 vcc, v4, v8
    s_nop 1
    v_cndmask_b32 v143, v15, v143, vcc
    v_cvt_pk_bf16_f32 v84, v128, v129
    v_max3_f32 v3, v3, v128, v129
    v_cvt_pk_bf16_f32 v85, v130, v131
    v_max3_f32 v3, v3, v130, v131
    v_cvt_pk_bf16_f32 v86, v132, v133
    v_max3_f32 v3, v3, v132, v133
    v_cvt_pk_bf16_f32 v87, v134, v135
    v_max3_f32 v3, v3, v134, v135
    v_cvt_pk_bf16_f32 v88, v136, v137
    v_max3_f32 v3, v3, v136, v137
    v_cvt_pk_bf16_f32 v89, v138, v139
    v_max3_f32 v3, v3, v138, v139
    v_cvt_pk_bf16_f32 v90, v140, v141
    v_max3_f32 v3, v3, v140, v141
    v_cvt_pk_bf16_f32 v91, v142, v143
    v_max3_f32 v3, v3, v142, v143
    s_branch K2_DN8
K2_SK8:
    v_mov_b32 v84, 0xf149f149
    v_mov_b32 v85, 0xf149f149
    v_mov_b32 v86, 0xf149f149
    v_mov_b32 v87, 0xf149f149
    v_mov_b32 v88, 0xf149f149
    v_mov_b32 v89, 0xf149f149
    v_mov_b32 v90, 0xf149f149
    v_mov_b32 v91, 0xf149f149
K2_DN8:
    s_cmp_lt_i32 s35, 1
    s_cbranch_scc0 K2_LV0
    s_mov_b32 s40, 0
    buffer_load_dwordx2 v[92:93], v13, s[28:31], s40 offen offset:0
    buffer_load_dwordx2 v[94:95], v13, s[28:31], s40 offen offset:16
    buffer_load_dwordx2 v[96:97], v13, s[28:31], s40 offen offset:32
    buffer_load_dwordx2 v[98:99], v13, s[28:31], s40 offen offset:48
K2_LV0:
    s_cmp_lt_i32 s35, 2
    s_cbranch_scc0 K2_LV1
    s_mov_b32 s40, 1024
    buffer_load_dwordx2 v[100:101], v13, s[28:31], s40 offen offset:0
    buffer_load_dwordx2 v[102:103], v13, s[28:31], s40 offen offset:16
    buffer_load_dwordx2 v[104:105], v13, s[28:31], s40 offen offset:32
    buffer_load_dwordx2 v[106:107], v13, s[28:31], s40 offen offset:48
K2_LV1:
    s_cmp_lt_i32 s35, 3
    s_cbranch_scc0 K2_LV2
    s_mov_b32 s40, 2048
    buffer_load_dwordx2 v[108:109], v13, s[28:31], s40 offen offset:0
    buffer_load_dwordx2 v[110:111], v13, s[28:31], s40 offen offset:16
    buffer_load_dwordx2 v[112:113], v13, s[28:31], s40 offen offset:32
    buffer_load_dwordx2 v[114:115], v13, s[28:31], s40 offen offset:48
K2_LV2:
    s_cmp_lt_i32 s35, 4
    s_cbranch_scc0 K2_LV3
    s_mov_b32 s40, 3072
    buffer_load_dwordx2 v[116:117], v13, s[28:31], s40 offen offset:0
    buffer_load_dwordx2 v[118:119], v13, s[28:31], s40 offen offset:16
    buffer_load_dwordx2 v[120:121], v13, s[28:31], s40 offen offset:32
    buffer_load_dwordx2 v[122:123], v13, s[28:31], s40 offen offset:48
K2_LV3:
    s_cmp_lt_i32 s35, 5
    s_cbranch_scc0 K2_LV4
    s_mov_b32 s40, 4096
    buffer_load_dwordx2 v[124:125], v13, s[28:31], s40 offen offset:0
    buffer_load_dwordx2 v[126:127], v13, s[28:31], s40 offen offset:16
    buffer_load_dwordx2 v[128:129], v13, s[28:31], s40 offen offset:32
    buffer_load_dwordx2 v[130:131], v13, s[28:31], s40 offen offset:48
K2_LV4:
    s_cmp_lt_i32 s35, 6
    s_cbranch_scc0 K2_LV5
    s_mov_b32 s40, 5120
    buffer_load_dwordx2 v[132:133], v13, s[28:31], s40 offen offset:0
    buffer_load_dwordx2 v[134:135], v13, s[28:31], s40 offen offset:16
    buffer_load_dwordx2 v[136:137], v13, s[28:31], s40 offen offset:32
    buffer_load_dwordx2 v[138:139], v13, s[28:31], s40 offen offset:48
K2_LV5:
    s_cmp_lt_i32 s35, 7
    s_cbranch_scc0 K2_LV6
    s_mov_b32 s40, 6144
    buffer_load_dwordx2 v[140:141], v13, s[28:31], s40 offen offset:0
    buffer_load_dwordx2 v[142:143], v13, s[28:31], s40 offen offset:16
    buffer_load_dwordx2 v[144:145], v13, s[28:31], s40 offen offset:32
    buffer_load_dwordx2 v[146:147], v13, s[28:31], s40 offen offset:48
K2_LV6:
    s_cmp_lt_i32 s35, 8
    s_cbranch_scc0 K2_LV7
    s_mov_b32 s40, 7168
    buffer_load_dwordx2 v[148:149], v13, s[28:31], s40 offen offset:0
    buffer_load_dwordx2 v[150:151], v13, s[28:31], s40 offen offset:16
    buffer_load_dwordx2 v[152:153], v13, s[28:31], s40 offen offset:32
    buffer_load_dwordx2 v[154:155], v13, s[28:31], s40 offen offset:48
K2_LV7:
    s_cmp_lt_i32 s35, 9
    s_cbranch_scc0 K2_LV8
    s_mov_b32 s40, 8192
    buffer_load_dwordx2 v[156:157], v13, s[28:31], s40 offen offset:0
    buffer_load_dwordx2 v[158:159], v13, s[28:31], s40 offen offset:16
    buffer_load_dwordx2 v[160:161], v13, s[28:31], s40 offen offset:32
    buffer_load_dwordx2 v[162:163], v13, s[28:31], s40 offen offset:48
K2_LV8:
    v_cvt_pk_bf16_f32 v3, v3, v3
    v_lshlrev_b32 v3, 16, v3
    ds_bpermute_b32 v4, v10, v3
    s_waitcnt lgkmcnt(0)
    v_max_f32 v3, v3, v4
    v_mov_b32 v5, 0x3eb8aa3b
    v_mul_f32 v3, v5, v3
    v_mov_b32 v6, 0
    v_mov_b32 v7, 0
    v_lshlrev_b32 v12, 16, v20
    v_and_b32 v13, 0xffff0000, v20
    v_lshlrev_b32 v14, 16, v21
    v_and_b32 v15, 0xffff0000, v21
    v_fma_f32 v12, v12, v5, -v3
    v_fma_f32 v13, v13, v5, -v3
    v_fma_f32 v14, v14, v5, -v3
    v_fma_f32 v15, v15, v5, -v3
    v_exp_f32 v12, v12
    v_exp_f32 v13, v13
    v_exp_f32 v14, v14
    v_exp_f32 v15, v15
    v_add_f32 v6, v6, v12
    v_add_f32 v7, v7, v13
    v_cvt_pk_bf16_f32 v20, v12, v13
    v_add_f32 v6, v6, v14
    v_add_f32 v7, v7, v15
    v_cvt_pk_bf16_f32 v21, v14, v15
    v_lshlrev_b32 v12, 16, v22
    v_and_b32 v13, 0xffff0000, v22
    v_lshlrev_b32 v14, 16, v23
    v_and_b32 v15, 0xffff0000, v23
    v_fma_f32 v12, v12, v5, -v3
    v_fma_f32 v13, v13, v5, -v3
    v_fma_f32 v14, v14, v5, -v3
    v_fma_f32 v15, v15, v5, -v3
    v_exp_f32 v12, v12
    v_exp_f32 v13, v13
    v_exp_f32 v14, v14
    v_exp_f32 v15, v15
    v_add_f32 v6, v6, v12
    v_add_f32 v7, v7, v13
    v_cvt_pk_bf16_f32 v22, v12, v13
    v_add_f32 v6, v6, v14
    v_add_f32 v7, v7, v15
    v_cvt_pk_bf16_f32 v23, v14, v15
    v_lshlrev_b32 v12, 16, v24
    v_and_b32 v13, 0xffff0000, v24
    v_lshlrev_b32 v14, 16, v25
    v_and_b32 v15, 0xffff0000, v25
    v_fma_f32 v12, v12, v5, -v3
    v_fma_f32 v13, v13, v5, -v3
    v_fma_f32 v14, v14, v5, -v3
    v_fma_f32 v15, v15, v5, -v3
    v_exp_f32 v12, v12
    v_exp_f32 v13, v13
    v_exp_f32 v14, v14
    v_exp_f32 v15, v15
    v_add_f32 v6, v6, v12
    v_add_f32 v7, v7, v13
    v_cvt_pk_bf16_f32 v24, v12, v13
    v_add_f32 v6, v6, v14
    v_add_f32 v7, v7, v15
    v_cvt_pk_bf16_f32 v25, v14, v15
    v_lshlrev_b32 v12, 16, v26
    v_and_b32 v13, 0xffff0000, v26
    v_lshlrev_b32 v14, 16, v27
    v_and_b32 v15, 0xffff0000, v27
    v_fma_f32 v12, v12, v5, -v3
    v_fma_f32 v13, v13, v5, -v3
    v_fma_f32 v14, v14, v5, -v3
    v_fma_f32 v15, v15, v5, -v3
    v_exp_f32 v12, v12
    v_exp_f32 v13, v13
    v_exp_f32 v14, v14
    v_exp_f32 v15, v15
    v_add_f32 v6, v6, v12
    v_add_f32 v7, v7, v13
    v_cvt_pk_bf16_f32 v26, v12, v13
    v_add_f32 v6, v6, v14
    v_add_f32 v7, v7, v15
    v_cvt_pk_bf16_f32 v27, v14, v15
    v_lshlrev_b32 v12, 16, v28
    v_and_b32 v13, 0xffff0000, v28
    v_lshlrev_b32 v14, 16, v29
    v_and_b32 v15, 0xffff0000, v29
    v_fma_f32 v12, v12, v5, -v3
    v_fma_f32 v13, v13, v5, -v3
    v_fma_f32 v14, v14, v5, -v3
    v_fma_f32 v15, v15, v5, -v3
    v_exp_f32 v12, v12
    v_exp_f32 v13, v13
    v_exp_f32 v14, v14
    v_exp_f32 v15, v15
    v_add_f32 v6, v6, v12
    v_add_f32 v7, v7, v13
    v_cvt_pk_bf16_f32 v28, v12, v13
    v_add_f32 v6, v6, v14
    v_add_f32 v7, v7, v15
    v_cvt_pk_bf16_f32 v29, v14, v15
    v_lshlrev_b32 v12, 16, v30
    v_and_b32 v13, 0xffff0000, v30
    v_lshlrev_b32 v14, 16, v31
    v_and_b32 v15, 0xffff0000, v31
    v_fma_f32 v12, v12, v5, -v3
    v_fma_f32 v13, v13, v5, -v3
    v_fma_f32 v14, v14, v5, -v3
    v_fma_f32 v15, v15, v5, -v3
    v_exp_f32 v12, v12
    v_exp_f32 v13, v13
    v_exp_f32 v14, v14
    v_exp_f32 v15, v15
    v_add_f32 v6, v6, v12
    v_add_f32 v7, v7, v13
    v_cvt_pk_bf16_f32 v30, v12, v13
    v_add_f32 v6, v6, v14
    v_add_f32 v7, v7, v15
    v_cvt_pk_bf16_f32 v31, v14, v15
    v_lshlrev_b32 v12, 16, v32
    v_and_b32 v13, 0xffff0000, v32
    v_lshlrev_b32 v14, 16, v33
    v_and_b32 v15, 0xffff0000, v33
    v_fma_f32 v12, v12, v5, -v3
    v_fma_f32 v13, v13, v5, -v3
    v_fma_f32 v14, v14, v5, -v3
    v_fma_f32 v15, v15, v5, -v3
    v_exp_f32 v12, v12
    v_exp_f32 v13, v13
    v_exp_f32 v14, v14
    v_exp_f32 v15, v15
    v_add_f32 v6, v6, v12
    v_add_f32 v7, v7, v13
    v_cvt_pk_bf16_f32 v32, v12, v13
    v_add_f32 v6, v6, v14
    v_add_f32 v7, v7, v15
    v_cvt_pk_bf16_f32 v33, v14, v15
    v_lshlrev_b32 v12, 16, v34
    v_and_b32 v13, 0xffff0000, v34
    v_lshlrev_b32 v14, 16, v35
    v_and_b32 v15, 0xffff0000, v35
    v_fma_f32 v12, v12, v5, -v3
    v_fma_f32 v13, v13, v5, -v3
    v_fma_f32 v14, v14, v5, -v3
    v_fma_f32 v15, v15, v5, -v3
    v_exp_f32 v12, v12
    v_exp_f32 v13, v13
    v_exp_f32 v14, v14
    v_exp_f32 v15, v15
    v_add_f32 v6, v6, v12
    v_add_f32 v7, v7, v13
    v_cvt_pk_bf16_f32 v34, v12, v13
    v_add_f32 v6, v6, v14
    v_add_f32 v7, v7, v15
    v_cvt_pk_bf16_f32 v35, v14, v15
    v_lshlrev_b32 v12, 16, v36
    v_and_b32 v13, 0xffff0000, v36
    v_lshlrev_b32 v14, 16, v37
    v_and_b32 v15, 0xffff0000, v37
    v_fma_f32 v12, v12, v5, -v3
    v_fma_f32 v13, v13, v5, -v3
    v_fma_f32 v14, v14, v5, -v3
    v_fma_f32 v15, v15, v5, -v3
    v_exp_f32 v12, v12
    v_exp_f32 v13, v13
    v_exp_f32 v14, v14
    v_exp_f32 v15, v15
    v_add_f32 v6, v6, v12
    v_add_f32 v7, v7, v13
    v_cvt_pk_bf16_f32 v36, v12, v13
    v_add_f32 v6, v6, v14
    v_add_f32 v7, v7, v15
    v_cvt_pk_bf16_f32 v37, v14, v15
    v_lshlrev_b32 v12, 16, v38
    v_and_b32 v13, 0xffff0000, v38
    v_lshlrev_b32 v14, 16, v39
    v_and_b32 v15, 0xffff0000, v39
    v_fma_f32 v12, v12, v5, -v3
    v_fma_f32 v13, v13, v5, -v3
    v_fma_f32 v14, v14, v5, -v3
    v_fma_f32 v15, v15, v5, -v3
    v_exp_f32 v12, v12
    v_exp_f32 v13, v13
    v_exp_f32 v14, v14
    v_exp_f32 v15, v15
    v_add_f32 v6, v6, v12
    v_add_f32 v7, v7, v13
    v_cvt_pk_bf16_f32 v38, v12, v13
    v_add_f32 v6, v6, v14
    v_add_f32 v7, v7, v15
    v_cvt_pk_bf16_f32 v39, v14, v15
    v_lshlrev_b32 v12, 16, v40
    v_and_b32 v13, 0xffff0000, v40
    v_lshlrev_b32 v14, 16, v41
    v_and_b32 v15, 0xffff0000, v41
    v_fma_f32 v12, v12, v5, -v3
    v_fma_f32 v13, v13, v5, -v3
    v_fma_f32 v14, v14, v5, -v3
    v_fma_f32 v15, v15, v5, -v3
    v_exp_f32 v12, v12
    v_exp_f32 v13, v13
    v_exp_f32 v14, v14
    v_exp_f32 v15, v15
    v_add_f32 v6, v6, v12
    v_add_f32 v7, v7, v13
    v_cvt_pk_bf16_f32 v40, v12, v13
    v_add_f32 v6, v6, v14
    v_add_f32 v7, v7, v15
    v_cvt_pk_bf16_f32 v41, v14, v15
    v_lshlrev_b32 v12, 16, v42
    v_and_b32 v13, 0xffff0000, v42
    v_lshlrev_b32 v14, 16, v43
    v_and_b32 v15, 0xffff0000, v43
    v_fma_f32 v12, v12, v5, -v3
    v_fma_f32 v13, v13, v5, -v3
    v_fma_f32 v14, v14, v5, -v3
    v_fma_f32 v15, v15, v5, -v3
    v_exp_f32 v12, v12
    v_exp_f32 v13, v13
    v_exp_f32 v14, v14
    v_exp_f32 v15, v15
    v_add_f32 v6, v6, v12
    v_add_f32 v7, v7, v13
    v_cvt_pk_bf16_f32 v42, v12, v13
    v_add_f32 v6, v6, v14
    v_add_f32 v7, v7, v15
    v_cvt_pk_bf16_f32 v43, v14, v15
    v_lshlrev_b32 v12, 16, v44
    v_and_b32 v13, 0xffff0000, v44
    v_lshlrev_b32 v14, 16, v45
    v_and_b32 v15, 0xffff0000, v45
    v_fma_f32 v12, v12, v5, -v3
    v_fma_f32 v13, v13, v5, -v3
    v_fma_f32 v14, v14, v5, -v3
    v_fma_f32 v15, v15, v5, -v3
    v_exp_f32 v12, v12
    v_exp_f32 v13, v13
    v_exp_f32 v14, v14
    v_exp_f32 v15, v15
    v_add_f32 v6, v6, v12
    v_add_f32 v7, v7, v13
    v_cvt_pk_bf16_f32 v44, v12, v13
    v_add_f32 v6, v6, v14
    v_add_f32 v7, v7, v15
    v_cvt_pk_bf16_f32 v45, v14, v15
    v_lshlrev_b32 v12, 16, v46
    v_and_b32 v13, 0xffff0000, v46
    v_lshlrev_b32 v14, 16, v47
    v_and_b32 v15, 0xffff0000, v47
    v_fma_f32 v12, v12, v5, -v3
    v_fma_f32 v13, v13, v5, -v3
    v_fma_f32 v14, v14, v5, -v3
    v_fma_f32 v15, v15, v5, -v3
    v_exp_f32 v12, v12
    v_exp_f32 v13, v13
    v_exp_f32 v14, v14
    v_exp_f32 v15, v15
    v_add_f32 v6, v6, v12
    v_add_f32 v7, v7, v13
    v_cvt_pk_bf16_f32 v46, v12, v13
    v_add_f32 v6, v6, v14
    v_add_f32 v7, v7, v15
    v_cvt_pk_bf16_f32 v47, v14, v15
    v_lshlrev_b32 v12, 16, v48
    v_and_b32 v13, 0xffff0000, v48
    v_lshlrev_b32 v14, 16, v49
    v_and_b32 v15, 0xffff0000, v49
    v_fma_f32 v12, v12, v5, -v3
    v_fma_f32 v13, v13, v5, -v3
    v_fma_f32 v14, v14, v5, -v3
    v_fma_f32 v15, v15, v5, -v3
    v_exp_f32 v12, v12
    v_exp_f32 v13, v13
    v_exp_f32 v14, v14
    v_exp_f32 v15, v15
    v_add_f32 v6, v6, v12
    v_add_f32 v7, v7, v13
    v_cvt_pk_bf16_f32 v48, v12, v13
    v_add_f32 v6, v6, v14
    v_add_f32 v7, v7, v15
    v_cvt_pk_bf16_f32 v49, v14, v15
    v_lshlrev_b32 v12, 16, v50
    v_and_b32 v13, 0xffff0000, v50
    v_lshlrev_b32 v14, 16, v51
    v_and_b32 v15, 0xffff0000, v51
    v_fma_f32 v12, v12, v5, -v3
    v_fma_f32 v13, v13, v5, -v3
    v_fma_f32 v14, v14, v5, -v3
    v_fma_f32 v15, v15, v5, -v3
    v_exp_f32 v12, v12
    v_exp_f32 v13, v13
    v_exp_f32 v14, v14
    v_exp_f32 v15, v15
    v_add_f32 v6, v6, v12
    v_add_f32 v7, v7, v13
    v_cvt_pk_bf16_f32 v50, v12, v13
    v_add_f32 v6, v6, v14
    v_add_f32 v7, v7, v15
    v_cvt_pk_bf16_f32 v51, v14, v15
    v_lshlrev_b32 v12, 16, v52
    v_and_b32 v13, 0xffff0000, v52
    v_lshlrev_b32 v14, 16, v53
    v_and_b32 v15, 0xffff0000, v53
    v_fma_f32 v12, v12, v5, -v3
    v_fma_f32 v13, v13, v5, -v3
    v_fma_f32 v14, v14, v5, -v3
    v_fma_f32 v15, v15, v5, -v3
    v_exp_f32 v12, v12
    v_exp_f32 v13, v13
    v_exp_f32 v14, v14
    v_exp_f32 v15, v15
    v_add_f32 v6, v6, v12
    v_add_f32 v7, v7, v13
    v_cvt_pk_bf16_f32 v52, v12, v13
    v_add_f32 v6, v6, v14
    v_add_f32 v7, v7, v15
    v_cvt_pk_bf16_f32 v53, v14, v15
    v_lshlrev_b32 v12, 16, v54
    v_and_b32 v13, 0xffff0000, v54
    v_lshlrev_b32 v14, 16, v55
    v_and_b32 v15, 0xffff0000, v55
    v_fma_f32 v12, v12, v5, -v3
    v_fma_f32 v13, v13, v5, -v3
    v_fma_f32 v14, v14, v5, -v3
    v_fma_f32 v15, v15, v5, -v3
    v_exp_f32 v12, v12
    v_exp_f32 v13, v13
    v_exp_f32 v14, v14
    v_exp_f32 v15, v15
    v_add_f32 v6, v6, v12
    v_add_f32 v7, v7, v13
    v_cvt_pk_bf16_f32 v54, v12, v13
    v_add_f32 v6, v6, v14
    v_add_f32 v7, v7, v15
    v_cvt_pk_bf16_f32 v55, v14, v15
    v_lshlrev_b32 v12, 16, v56
    v_and_b32 v13, 0xffff0000, v56
    v_lshlrev_b32 v14, 16, v57
    v_and_b32 v15, 0xffff0000, v57
    v_fma_f32 v12, v12, v5, -v3
    v_fma_f32 v13, v13, v5, -v3
    v_fma_f32 v14, v14, v5, -v3
    v_fma_f32 v15, v15, v5, -v3
    v_exp_f32 v12, v12
    v_exp_f32 v13, v13
    v_exp_f32 v14, v14
    v_exp_f32 v15, v15
    v_add_f32 v6, v6, v12
    v_add_f32 v7, v7, v13
    v_cvt_pk_bf16_f32 v56, v12, v13
    v_add_f32 v6, v6, v14
    v_add_f32 v7, v7, v15
    v_cvt_pk_bf16_f32 v57, v14, v15
    v_lshlrev_b32 v12, 16, v58
    v_and_b32 v13, 0xffff0000, v58
    v_lshlrev_b32 v14, 16, v59
    v_and_b32 v15, 0xffff0000, v59
    v_fma_f32 v12, v12, v5, -v3
    v_fma_f32 v13, v13, v5, -v3
    v_fma_f32 v14, v14, v5, -v3
    v_fma_f32 v15, v15, v5, -v3
    v_exp_f32 v12, v12
    v_exp_f32 v13, v13
    v_exp_f32 v14, v14
    v_exp_f32 v15, v15
    v_add_f32 v6, v6, v12
    v_add_f32 v7, v7, v13
    v_cvt_pk_bf16_f32 v58, v12, v13
    v_add_f32 v6, v6, v14
    v_add_f32 v7, v7, v15
    v_cvt_pk_bf16_f32 v59, v14, v15
    v_lshlrev_b32 v12, 16, v60
    v_and_b32 v13, 0xffff0000, v60
    v_lshlrev_b32 v14, 16, v61
    v_and_b32 v15, 0xffff0000, v61
    v_fma_f32 v12, v12, v5, -v3
    v_fma_f32 v13, v13, v5, -v3
    v_fma_f32 v14, v14, v5, -v3
    v_fma_f32 v15, v15, v5, -v3
    v_exp_f32 v12, v12
    v_exp_f32 v13, v13
    v_exp_f32 v14, v14
    v_exp_f32 v15, v15
    v_add_f32 v6, v6, v12
    v_add_f32 v7, v7, v13
    v_cvt_pk_bf16_f32 v60, v12, v13
    v_add_f32 v6, v6, v14
    v_add_f32 v7, v7, v15
    v_cvt_pk_bf16_f32 v61, v14, v15
    v_lshlrev_b32 v12, 16, v62
    v_and_b32 v13, 0xffff0000, v62
    v_lshlrev_b32 v14, 16, v63
    v_and_b32 v15, 0xffff0000, v63
    v_fma_f32 v12, v12, v5, -v3
    v_fma_f32 v13, v13, v5, -v3
    v_fma_f32 v14, v14, v5, -v3
    v_fma_f32 v15, v15, v5, -v3
    v_exp_f32 v12, v12
    v_exp_f32 v13, v13
    v_exp_f32 v14, v14
    v_exp_f32 v15, v15
    v_add_f32 v6, v6, v12
    v_add_f32 v7, v7, v13
    v_cvt_pk_bf16_f32 v62, v12, v13
    v_add_f32 v6, v6, v14
    v_add_f32 v7, v7, v15
    v_cvt_pk_bf16_f32 v63, v14, v15
    v_lshlrev_b32 v12, 16, v64
    v_and_b32 v13, 0xffff0000, v64
    v_lshlrev_b32 v14, 16, v65
    v_and_b32 v15, 0xffff0000, v65
    v_fma_f32 v12, v12, v5, -v3
    v_fma_f32 v13, v13, v5, -v3
    v_fma_f32 v14, v14, v5, -v3
    v_fma_f32 v15, v15, v5, -v3
    v_exp_f32 v12, v12
    v_exp_f32 v13, v13
    v_exp_f32 v14, v14
    v_exp_f32 v15, v15
    v_add_f32 v6, v6, v12
    v_add_f32 v7, v7, v13
    v_cvt_pk_bf16_f32 v64, v12, v13
    v_add_f32 v6, v6, v14
    v_add_f32 v7, v7, v15
    v_cvt_pk_bf16_f32 v65, v14, v15
    v_lshlrev_b32 v12, 16, v66
    v_and_b32 v13, 0xffff0000, v66
    v_lshlrev_b32 v14, 16, v67
    v_and_b32 v15, 0xffff0000, v67
    v_fma_f32 v12, v12, v5, -v3
    v_fma_f32 v13, v13, v5, -v3
    v_fma_f32 v14, v14, v5, -v3
    v_fma_f32 v15, v15, v5, -v3
    v_exp_f32 v12, v12
    v_exp_f32 v13, v13
    v_exp_f32 v14, v14
    v_exp_f32 v15, v15
    v_add_f32 v6, v6, v12
    v_add_f32 v7, v7, v13
    v_cvt_pk_bf16_f32 v66, v12, v13
    v_add_f32 v6, v6, v14
    v_add_f32 v7, v7, v15
    v_cvt_pk_bf16_f32 v67, v14, v15
    v_lshlrev_b32 v12, 16, v68
    v_and_b32 v13, 0xffff0000, v68
    v_lshlrev_b32 v14, 16, v69
    v_and_b32 v15, 0xffff0000, v69
    v_fma_f32 v12, v12, v5, -v3
    v_fma_f32 v13, v13, v5, -v3
    v_fma_f32 v14, v14, v5, -v3
    v_fma_f32 v15, v15, v5, -v3
    v_exp_f32 v12, v12
    v_exp_f32 v13, v13
    v_exp_f32 v14, v14
    v_exp_f32 v15, v15
    v_add_f32 v6, v6, v12
    v_add_f32 v7, v7, v13
    v_cvt_pk_bf16_f32 v68, v12, v13
    v_add_f32 v6, v6, v14
    v_add_f32 v7, v7, v15
    v_cvt_pk_bf16_f32 v69, v14, v15
    v_lshlrev_b32 v12, 16, v70
    v_and_b32 v13, 0xffff0000, v70
    v_lshlrev_b32 v14, 16, v71
    v_and_b32 v15, 0xffff0000, v71
    v_fma_f32 v12, v12, v5, -v3
    v_fma_f32 v13, v13, v5, -v3
    v_fma_f32 v14, v14, v5, -v3
    v_fma_f32 v15, v15, v5, -v3
    v_exp_f32 v12, v12
    v_exp_f32 v13, v13
    v_exp_f32 v14, v14
    v_exp_f32 v15, v15
    v_add_f32 v6, v6, v12
    v_add_f32 v7, v7, v13
    v_cvt_pk_bf16_f32 v70, v12, v13
    v_add_f32 v6, v6, v14
    v_add_f32 v7, v7, v15
    v_cvt_pk_bf16_f32 v71, v14, v15
    v_lshlrev_b32 v12, 16, v72
    v_and_b32 v13, 0xffff0000, v72
    v_lshlrev_b32 v14, 16, v73
    v_and_b32 v15, 0xffff0000, v73
    v_fma_f32 v12, v12, v5, -v3
    v_fma_f32 v13, v13, v5, -v3
    v_fma_f32 v14, v14, v5, -v3
    v_fma_f32 v15, v15, v5, -v3
    v_exp_f32 v12, v12
    v_exp_f32 v13, v13
    v_exp_f32 v14, v14
    v_exp_f32 v15, v15
    v_add_f32 v6, v6, v12
    v_add_f32 v7, v7, v13
    v_cvt_pk_bf16_f32 v72, v12, v13
    v_add_f32 v6, v6, v14
    v_add_f32 v7, v7, v15
    v_cvt_pk_bf16_f32 v73, v14, v15
    v_lshlrev_b32 v12, 16, v74
    v_and_b32 v13, 0xffff0000, v74
    v_lshlrev_b32 v14, 16, v75
    v_and_b32 v15, 0xffff0000, v75
    v_fma_f32 v12, v12, v5, -v3
    v_fma_f32 v13, v13, v5, -v3
    v_fma_f32 v14, v14, v5, -v3
    v_fma_f32 v15, v15, v5, -v3
    v_exp_f32 v12, v12
    v_exp_f32 v13, v13
    v_exp_f32 v14, v14
    v_exp_f32 v15, v15
    v_add_f32 v6, v6, v12
    v_add_f32 v7, v7, v13
    v_cvt_pk_bf16_f32 v74, v12, v13
    v_add_f32 v6, v6, v14
    v_add_f32 v7, v7, v15
    v_cvt_pk_bf16_f32 v75, v14, v15
    v_lshlrev_b32 v12, 16, v76
    v_and_b32 v13, 0xffff0000, v76
    v_lshlrev_b32 v14, 16, v77
    v_and_b32 v15, 0xffff0000, v77
    v_fma_f32 v12, v12, v5, -v3
    v_fma_f32 v13, v13, v5, -v3
    v_fma_f32 v14, v14, v5, -v3
    v_fma_f32 v15, v15, v5, -v3
    v_exp_f32 v12, v12
    v_exp_f32 v13, v13
    v_exp_f32 v14, v14
    v_exp_f32 v15, v15
    v_add_f32 v6, v6, v12
    v_add_f32 v7, v7, v13
    v_cvt_pk_bf16_f32 v76, v12, v13
    v_add_f32 v6, v6, v14
    v_add_f32 v7, v7, v15
    v_cvt_pk_bf16_f32 v77, v14, v15
    v_lshlrev_b32 v12, 16, v78
    v_and_b32 v13, 0xffff0000, v78
    v_lshlrev_b32 v14, 16, v79
    v_and_b32 v15, 0xffff0000, v79
    v_fma_f32 v12, v12, v5, -v3
    v_fma_f32 v13, v13, v5, -v3
    v_fma_f32 v14, v14, v5, -v3
    v_fma_f32 v15, v15, v5, -v3
    v_exp_f32 v12, v12
    v_exp_f32 v13, v13
    v_exp_f32 v14, v14
    v_exp_f32 v15, v15
    v_add_f32 v6, v6, v12
    v_add_f32 v7, v7, v13
    v_cvt_pk_bf16_f32 v78, v12, v13
    v_add_f32 v6, v6, v14
    v_add_f32 v7, v7, v15
    v_cvt_pk_bf16_f32 v79, v14, v15
    v_lshlrev_b32 v12, 16, v80
    v_and_b32 v13, 0xffff0000, v80
    v_lshlrev_b32 v14, 16, v81
    v_and_b32 v15, 0xffff0000, v81
    v_fma_f32 v12, v12, v5, -v3
    v_fma_f32 v13, v13, v5, -v3
    v_fma_f32 v14, v14, v5, -v3
    v_fma_f32 v15, v15, v5, -v3
    v_exp_f32 v12, v12
    v_exp_f32 v13, v13
    v_exp_f32 v14, v14
    v_exp_f32 v15, v15
    v_add_f32 v6, v6, v12
    v_add_f32 v7, v7, v13
    v_cvt_pk_bf16_f32 v80, v12, v13
    v_add_f32 v6, v6, v14
    v_add_f32 v7, v7, v15
    v_cvt_pk_bf16_f32 v81, v14, v15
    v_lshlrev_b32 v12, 16, v82
    v_and_b32 v13, 0xffff0000, v82
    v_lshlrev_b32 v14, 16, v83
    v_and_b32 v15, 0xffff0000, v83
    v_fma_f32 v12, v12, v5, -v3
    v_fma_f32 v13, v13, v5, -v3
    v_fma_f32 v14, v14, v5, -v3
    v_fma_f32 v15, v15, v5, -v3
    v_exp_f32 v12, v12
    v_exp_f32 v13, v13
    v_exp_f32 v14, v14
    v_exp_f32 v15, v15
    v_add_f32 v6, v6, v12
    v_add_f32 v7, v7, v13
    v_cvt_pk_bf16_f32 v82, v12, v13
    v_add_f32 v6, v6, v14
    v_add_f32 v7, v7, v15
    v_cvt_pk_bf16_f32 v83, v14, v15
    v_lshlrev_b32 v12, 16, v84
    v_and_b32 v13, 0xffff0000, v84
    v_lshlrev_b32 v14, 16, v85
    v_and_b32 v15, 0xffff0000, v85
    v_fma_f32 v12, v12, v5, -v3
    v_fma_f32 v13, v13, v5, -v3
    v_fma_f32 v14, v14, v5, -v3
    v_fma_f32 v15, v15, v5, -v3
    v_exp_f32 v12, v12
    v_exp_f32 v13, v13
    v_exp_f32 v14, v14
    v_exp_f32 v15, v15
    v_add_f32 v6, v6, v12
    v_add_f32 v7, v7, v13
    v_cvt_pk_bf16_f32 v84, v12, v13
    v_add_f32 v6, v6, v14
    v_add_f32 v7, v7, v15
    v_cvt_pk_bf16_f32 v85, v14, v15
    v_lshlrev_b32 v12, 16, v86
    v_and_b32 v13, 0xffff0000, v86
    v_lshlrev_b32 v14, 16, v87
    v_and_b32 v15, 0xffff0000, v87
    v_fma_f32 v12, v12, v5, -v3
    v_fma_f32 v13, v13, v5, -v3
    v_fma_f32 v14, v14, v5, -v3
    v_fma_f32 v15, v15, v5, -v3
    v_exp_f32 v12, v12
    v_exp_f32 v13, v13
    v_exp_f32 v14, v14
    v_exp_f32 v15, v15
    v_add_f32 v6, v6, v12
    v_add_f32 v7, v7, v13
    v_cvt_pk_bf16_f32 v86, v12, v13
    v_add_f32 v6, v6, v14
    v_add_f32 v7, v7, v15
    v_cvt_pk_bf16_f32 v87, v14, v15
    v_lshlrev_b32 v12, 16, v88
    v_and_b32 v13, 0xffff0000, v88
    v_lshlrev_b32 v14, 16, v89
    v_and_b32 v15, 0xffff0000, v89
    v_fma_f32 v12, v12, v5, -v3
    v_fma_f32 v13, v13, v5, -v3
    v_fma_f32 v14, v14, v5, -v3
    v_fma_f32 v15, v15, v5, -v3
    v_exp_f32 v12, v12
    v_exp_f32 v13, v13
    v_exp_f32 v14, v14
    v_exp_f32 v15, v15
    v_add_f32 v6, v6, v12
    v_add_f32 v7, v7, v13
    v_cvt_pk_bf16_f32 v88, v12, v13
    v_add_f32 v6, v6, v14
    v_add_f32 v7, v7, v15
    v_cvt_pk_bf16_f32 v89, v14, v15
    v_lshlrev_b32 v12, 16, v90
    v_and_b32 v13, 0xffff0000, v90
    v_lshlrev_b32 v14, 16, v91
    v_and_b32 v15, 0xffff0000, v91
    v_fma_f32 v12, v12, v5, -v3
    v_fma_f32 v13, v13, v5, -v3
    v_fma_f32 v14, v14, v5, -v3
    v_fma_f32 v15, v15, v5, -v3
    v_exp_f32 v12, v12
    v_exp_f32 v13, v13
    v_exp_f32 v14, v14
    v_exp_f32 v15, v15
    v_add_f32 v6, v6, v12
    v_add_f32 v7, v7, v13
    v_cvt_pk_bf16_f32 v90, v12, v13
    v_add_f32 v6, v6, v14
    v_add_f32 v7, v7, v15
    v_cvt_pk_bf16_f32 v91, v14, v15
    v_add_f32 v6, v6, v7
    ds_bpermute_b32 v4, v10, v6
    v_add_u32 v17, s3, v8
    v_lshlrev_b32 v17, 10, v17
    v_lshl_add_u32 v17, v9, 3, v17
    s_lshl_b32 s38, s36, 5
    s_add_u32 s38, s38, 9437184
    v_add_u32 v17, s38, v17
    s_waitcnt vmcnt(0) lgkmcnt(0)
    v_add_f32 v6, v6, v4
    v_rcp_f32 v16, v6
    v_mov_b32 v0, 0
    v_mov_b32 v1, 0
    v_mov_b32 v2, 0
    v_mov_b32 v3, 0
    v_mov_b32 v4, 0
    v_mov_b32 v5, 0
    v_mov_b32 v6, 0
    v_mov_b32 v7, 0
    v_mov_b32 v8, 0
    v_mov_b32 v9, 0
    v_mov_b32 v10, 0
    v_mov_b32 v11, 0
    v_mov_b32 v12, 0
    v_mov_b32 v13, 0
    v_mov_b32 v14, 0
    v_mov_b32 v15, 0
    s_nop 1
    s_cmp_lt_i32 s35, 1
    s_cbranch_scc0 K2_SV0
    v_mfma_f32_32x32x16_bf16 v[0:15], v[92:95], v[20:23], v[0:15]
    v_mfma_f32_32x32x16_bf16 v[0:15], v[96:99], v[24:27], v[0:15]
K2_SV0:
    s_cmp_lt_i32 s35, 2
    s_cbranch_scc0 K2_SV1
    v_mfma_f32_32x32x16_bf16 v[0:15], v[100:103], v[28:31], v[0:15]
    v_mfma_f32_32x32x16_bf16 v[0:15], v[104:107], v[32:35], v[0:15]
K2_SV1:
    s_cmp_lt_i32 s35, 3
    s_cbranch_scc0 K2_SV2
    v_mfma_f32_32x32x16_bf16 v[0:15], v[108:111], v[36:39], v[0:15]
    v_mfma_f32_32x32x16_bf16 v[0:15], v[112:115], v[40:43], v[0:15]
K2_SV2:
    s_cmp_lt_i32 s35, 4
    s_cbranch_scc0 K2_SV3
    v_mfma_f32_32x32x16_bf16 v[0:15], v[116:119], v[44:47], v[0:15]
    v_mfma_f32_32x32x16_bf16 v[0:15], v[120:123], v[48:51], v[0:15]
K2_SV3:
    s_cmp_lt_i32 s35, 5
    s_cbranch_scc0 K2_SV4
    v_mfma_f32_32x32x16_bf16 v[0:15], v[124:127], v[52:55], v[0:15]
    v_mfma_f32_32x32x16_bf16 v[0:15], v[128:131], v[56:59], v[0:15]
K2_SV4:
    s_cmp_lt_i32 s35, 6
    s_cbranch_scc0 K2_SV5
    v_mfma_f32_32x32x16_bf16 v[0:15], v[132:135], v[60:63], v[0:15]
    v_mfma_f32_32x32x16_bf16 v[0:15], v[136:139], v[64:67], v[0:15]
K2_SV5:
    s_cmp_lt_i32 s35, 7
    s_cbranch_scc0 K2_SV6
    v_mfma_f32_32x32x16_bf16 v[0:15], v[140:143], v[68:71], v[0:15]
    v_mfma_f32_32x32x16_bf16 v[0:15], v[144:147], v[72:75], v[0:15]
K2_SV6:
    s_cmp_lt_i32 s35, 8
    s_cbranch_scc0 K2_SV7
    v_mfma_f32_32x32x16_bf16 v[0:15], v[148:151], v[76:79], v[0:15]
    v_mfma_f32_32x32x16_bf16 v[0:15], v[152:155], v[80:83], v[0:15]
K2_SV7:
    s_cmp_lt_i32 s35, 9
    s_cbranch_scc0 K2_SV8
    v_mfma_f32_32x32x16_bf16 v[0:15], v[156:159], v[84:87], v[0:15]
    v_mfma_f32_32x32x16_bf16 v[0:15], v[160:163], v[88:91], v[0:15]
K2_SV8:
    s_nop 7
    s_nop 7
    v_mul_f32 v0, v0, v16
    v_mul_f32 v1, v1, v16
    v_mul_f32 v2, v2, v16
    v_mul_f32 v3, v3, v16
    v_mul_f32 v4, v4, v16
    v_mul_f32 v5, v5, v16
    v_mul_f32 v6, v6, v16
    v_mul_f32 v7, v7, v16
    v_cvt_pk_bf16_f32 v0, v0, v1
    v_cvt_pk_bf16_f32 v1, v2, v3
    v_cvt_pk_bf16_f32 v2, v4, v5
    v_cvt_pk_bf16_f32 v3, v6, v7
    buffer_store_dwordx2 v[0:1], v17, s[28:31], 0 offen
    buffer_store_dwordx2 v[2:3], v17, s[28:31], 0 offen offset:16
    s_endpgm
K2_CONV:
    s_mov_b32 s36, s16
    s_and_b32 s37, s17, 0xffff
    s_mov_b32 s38, 2097152
    s_mov_b32 s39, 0x00020000
    s_lshl_b32 s3, s2, 1
    s_lshl_b32 s41, s3, 1
    s_load_dword s48, s[18:19], s41
    s_lshl_b32 s43, s3, 12
    v_lshlrev_b32 v5, 4, v0
    buffer_load_dwordx4 v[40:43], v5, s[36:39], s43 offen
    s_add_u32 s44, s43, 12582912
    buffer_load_dwordx4 v[48:51], v5, s[28:31], s44 offen
    s_add_u32 s43, s43, 4096
    buffer_load_dwordx4 v[44:47], v5, s[36:39], s43 offen
    s_add_u32 s44, s44, 4096
    buffer_load_dwordx4 v[52:55], v5, s[28:31], s44 offen
    v_mov_b32 v56, 0
    v_mov_b32 v57, 0
    v_mov_b32 v58, 0
    v_mov_b32 v59, 0
    v_cmp_gt_u32 vcc, 128, v0
    s_and_saveexec_b64 s[50:51], vcc
    ds_write_b128 v5, v[56:59] offset:16704
    ds_write_b128 v5, v[56:59] offset:39552
    s_mov_b64 exec, s[50:51]
    v_cmp_gt_u32 vcc, 32, v0
    s_and_saveexec_b64 s[50:51], vcc
    v_lshrrev_b32 v6, 2, v0
    v_and_b32 v7, 3, v0
    v_lshrrev_b32 v8, 2, v6
    v_and_b32 v9, 3, v6
    v_mul_u32_u24 v8, 22848, v8
    v_mul_u32_u24 v9, 4176, v9
    v_add_u32 v8, v8, v9
    v_lshl_add_u32 v8, v7, 4, v8
    ds_write_b128 v8, v[56:59]
    s_mov_b64 exec, s[50:51]
    s_waitcnt lgkmcnt(0)
    s_barrier
    s_waitcnt vmcnt(0)
    ds_write_b128 v5, v[48:51] offset:18752
    ds_write_b128 v5, v[52:55] offset:41600
    ds_write_b128 v5, v[40:43] offset:64
    ds_write_b32 v5, v40 offset:8412
    ds_write_b32 v5, v41 offset:8416
    ds_write_b32 v5, v42 offset:8420
    ds_write_b32 v5, v43 offset:8424
    ds_write_b16 v5, v40 offset:4238
    ds_write_b16_d16_hi v5, v40 offset:4240
    ds_write_b16 v5, v41 offset:4242
    ds_write_b16_d16_hi v5, v41 offset:4244
    ds_write_b16 v5, v42 offset:4246
    ds_write_b16_d16_hi v5, v42 offset:4248
    ds_write_b16 v5, v43 offset:4250
    ds_write_b16_d16_hi v5, v43 offset:4252
    ds_write_b16 v5, v40 offset:12586
    ds_write_b16_d16_hi v5, v40 offset:12588
    ds_write_b16 v5, v41 offset:12590
    ds_write_b16_d16_hi v5, v41 offset:12592
    ds_write_b16 v5, v42 offset:12594
    ds_write_b16_d16_hi v5, v42 offset:12596
    ds_write_b16 v5, v43 offset:12598
    ds_write_b16_d16_hi v5, v43 offset:12600
    ds_write_b128 v5, v[44:47] offset:22912
    ds_write_b32 v5, v44 offset:31260
    ds_write_b32 v5, v45 offset:31264
    ds_write_b32 v5, v46 offset:31268
    ds_write_b32 v5, v47 offset:31272
    ds_write_b16 v5, v44 offset:27086
    ds_write_b16_d16_hi v5, v44 offset:27088
    ds_write_b16 v5, v45 offset:27090
    ds_write_b16_d16_hi v5, v45 offset:27092
    ds_write_b16 v5, v46 offset:27094
    ds_write_b16_d16_hi v5, v46 offset:27096
    ds_write_b16 v5, v47 offset:27098
    ds_write_b16_d16_hi v5, v47 offset:27100
    ds_write_b16 v5, v44 offset:35434
    ds_write_b16_d16_hi v5, v44 offset:35436
    ds_write_b16 v5, v45 offset:35438
    ds_write_b16_d16_hi v5, v45 offset:35440
    ds_write_b16 v5, v46 offset:35442
    ds_write_b16_d16_hi v5, v46 offset:35444
    ds_write_b16 v5, v47 offset:35446
    ds_write_b16_d16_hi v5, v47 offset:35448
    s_waitcnt lgkmcnt(0)
    s_barrier
    s_lshr_b32 s61, s32, 1
    s_and_b32 s62, s32, 1
    s_mul_i32 s63, s61, 22848
    v_and_b32 v8, 31, v1
    v_lshrrev_b32 v9, 5, v1
    v_add_u32 v10, 1, v8
    v_and_b32 v10, 3, v10
    v_add_u32 v11, 25, v8
    v_sub_u32 v11, v11, v10
    v_lshlrev_b32 v13, 3, v9
    v_sub_u32 v11, v11, v13
    v_mul_u32_u24 v12, 4176, v10
    v_lshl_add_u32 v12, v11, 1, v12
    v_add_u32 v12, s63, v12
    v_subrev_u32 v12, 32, v12
    s_lshl_b32 s64, s62, 5
    v_add_u32 v13, s64, v8
    v_lshlrev_b32 v13, 2, v13
    v_add_u32 v13, v13, v9
    v_lshlrev_b32 v13, 4, v13
    s_add_u32 s65, s63, 18752
    v_add_u32 v13, s65, v13
    v_mov_b32 v32, 0
    v_mov_b32 v33, 0
    v_mov_b32 v34, 0
    v_mov_b32 v35, 0
    v_mov_b32 v36, 0
    v_mov_b32 v37, 0
    v_mov_b32 v38, 0
    v_mov_b32 v39, 0
    v_mov_b32 v40, 0
    v_mov_b32 v41, 0
    v_mov_b32 v42, 0
    v_mov_b32 v43, 0
    v_mov_b32 v44, 0
    v_mov_b32 v45, 0
    v_mov_b32 v46, 0
    v_mov_b32 v47, 0
    s_lshl_b32 s66, s62, 5
    s_add_u32 s66, s66, 32
    s_mov_b32 s67, 0
    ds_read_b64 v[16:17], v12 offset:32
    ds_read_b64 v[18:19], v12 offset:40
    ds_read_b128 v[20:23], v13
    ds_read_b64 v[24:25], v12
    ds_read_b64 v[26:27], v12 offset:8
    ds_read_b128 v[28:31], v13 offset:32
    v_add_u32 v12, 64, v12
    v_subrev_u32 v13, 64, v13
    ds_read_b64 v[64:65], v12 offset:32
    ds_read_b64 v[66:67], v12 offset:40
    ds_read_b128 v[68:71], v13
    ds_read_b64 v[72:73], v12
    ds_read_b64 v[74:75], v12 offset:8
    ds_read_b128 v[76:79], v13 offset:32
    v_add_u32 v12, 64, v12
    v_subrev_u32 v13, 64, v13
K2_CONV_LOOP:
    s_waitcnt lgkmcnt(6)
    v_mfma_f32_32x32x16_bf16 v[32:47], v[16:19], v[20:23], v[32:47]
    v_mfma_f32_32x32x16_bf16 v[32:47], v[24:27], v[28:31], v[32:47]
    ds_read_b64 v[16:17], v12 offset:32
    ds_read_b64 v[18:19], v12 offset:40
    ds_read_b128 v[20:23], v13
    ds_read_b64 v[24:25], v12
    ds_read_b64 v[26:27], v12 offset:8
    ds_read_b128 v[28:31], v13 offset:32
    v_add_u32 v12, 64, v12
    v_subrev_u32 v13, 64, v13
    s_waitcnt lgkmcnt(6)
    v_mfma_f32_32x32x16_bf16 v[32:47], v[64:67], v[68:71], v[32:47]
    v_mfma_f32_32x32x16_bf16 v[32:47], v[72:75], v[76:79], v[32:47]
    ds_read_b64 v[64:65], v12 offset:32
    ds_read_b64 v[66:67], v12 offset:40
    ds_read_b128 v[68:71], v13
    ds_read_b64 v[72:73], v12
    ds_read_b64 v[74:75], v12 offset:8
    ds_read_b128 v[76:79], v13 offset:32
    v_add_u32 v12, 64, v12
    v_subrev_u32 v13, 64, v13
    s_add_u32 s67, s67, 2
    s_cmp_lt_u32 s67, s66
    s_cbranch_scc1 K2_CONV_LOOP
    s_waitcnt lgkmcnt(0)
    s_nop 7
    s_nop 7
    s_lshl_b32 s68, s61, 4
    s_lshr_b32 s68, s48, s68
    s_lshl_b32 s68, s68, 16
    v_add_u32 v13, s64, v8
    v_lshlrev_b32 v14, 6, v13
    v_add_u32 v14, s65, v14
    v_sub_u32 v15, 1, v9
    v_lshl_add_u32 v14, v15, 3, v14
    ds_read_b64 v[16:17], v14 offset:0
    ds_read_b64 v[18:19], v14 offset:16
    ds_read_b64 v[20:21], v14 offset:32
    ds_read_b64 v[22:23], v14 offset:48
    s_add_u32 s69, s3, s61
    s_lshl_b32 s69, s69, 12
    s_add_u32 s69, s69, 6291456
    v_lshlrev_b32 v15, 6, v13
    v_lshl_add_u32 v15, v9, 3, v15
    v_add_u32 v15, s69, v15
    s_waitcnt lgkmcnt(0)
    v_and_b32 v48, 0xffff0000, v17
    v_lshlrev_b32 v49, 16, v17
    v_and_b32 v50, 0xffff0000, v16
    v_lshlrev_b32 v51, 16, v16
    v_mul_f32 v48, s68, v48
    v_cvt_pk_bf16_f32 v48, v48, v48
    v_lshlrev_b32 v48, 16, v48
    v_cvt_pk_bf16_f32 v52, v32, v32
    v_lshlrev_b32 v52, 16, v52
    v_add_f32 v48, v48, v52
    v_mul_f32 v49, s68, v49
    v_cvt_pk_bf16_f32 v49, v49, v49
    v_lshlrev_b32 v49, 16, v49
    v_cvt_pk_bf16_f32 v53, v33, v33
    v_lshlrev_b32 v53, 16, v53
    v_add_f32 v49, v49, v53
    v_mul_f32 v50, s68, v50
    v_cvt_pk_bf16_f32 v50, v50, v50
    v_lshlrev_b32 v50, 16, v50
    v_cvt_pk_bf16_f32 v54, v34, v34
    v_lshlrev_b32 v54, 16, v54
    v_add_f32 v50, v50, v54
    v_mul_f32 v51, s68, v51
    v_cvt_pk_bf16_f32 v51, v51, v51
    v_lshlrev_b32 v51, 16, v51
    v_cvt_pk_bf16_f32 v55, v35, v35
    v_lshlrev_b32 v55, 16, v55
    v_add_f32 v51, v51, v55
    v_cvt_pk_bf16_f32 v56, v48, v49
    v_cvt_pk_bf16_f32 v57, v50, v51
    buffer_store_dwordx2 v[56:57], v15, s[28:31], 0 offen offset:0
    v_and_b32 v48, 0xffff0000, v19
    v_lshlrev_b32 v49, 16, v19
    v_and_b32 v50, 0xffff0000, v18
    v_lshlrev_b32 v51, 16, v18
    v_mul_f32 v48, s68, v48
    v_cvt_pk_bf16_f32 v48, v48, v48
    v_lshlrev_b32 v48, 16, v48
    v_cvt_pk_bf16_f32 v52, v36, v36
    v_lshlrev_b32 v52, 16, v52
    v_add_f32 v48, v48, v52
    v_mul_f32 v49, s68, v49
    v_cvt_pk_bf16_f32 v49, v49, v49
    v_lshlrev_b32 v49, 16, v49
    v_cvt_pk_bf16_f32 v53, v37, v37
    v_lshlrev_b32 v53, 16, v53
    v_add_f32 v49, v49, v53
    v_mul_f32 v50, s68, v50
    v_cvt_pk_bf16_f32 v50, v50, v50
    v_lshlrev_b32 v50, 16, v50
    v_cvt_pk_bf16_f32 v54, v38, v38
    v_lshlrev_b32 v54, 16, v54
    v_add_f32 v50, v50, v54
    v_mul_f32 v51, s68, v51
    v_cvt_pk_bf16_f32 v51, v51, v51
    v_lshlrev_b32 v51, 16, v51
    v_cvt_pk_bf16_f32 v55, v39, v39
    v_lshlrev_b32 v55, 16, v55
    v_add_f32 v51, v51, v55
    v_cvt_pk_bf16_f32 v58, v48, v49
    v_cvt_pk_bf16_f32 v59, v50, v51
    buffer_store_dwordx2 v[58:59], v15, s[28:31], 0 offen offset:16
    v_and_b32 v48, 0xffff0000, v21
    v_lshlrev_b32 v49, 16, v21
    v_and_b32 v50, 0xffff0000, v20
    v_lshlrev_b32 v51, 16, v20
    v_mul_f32 v48, s68, v48
    v_cvt_pk_bf16_f32 v48, v48, v48
    v_lshlrev_b32 v48, 16, v48
    v_cvt_pk_bf16_f32 v52, v40, v40
    v_lshlrev_b32 v52, 16, v52
    v_add_f32 v48, v48, v52
    v_mul_f32 v49, s68, v49
    v_cvt_pk_bf16_f32 v49, v49, v49
    v_lshlrev_b32 v49, 16, v49
    v_cvt_pk_bf16_f32 v53, v41, v41
    v_lshlrev_b32 v53, 16, v53
    v_add_f32 v49, v49, v53
    v_mul_f32 v50, s68, v50
    v_cvt_pk_bf16_f32 v50, v50, v50
    v_lshlrev_b32 v50, 16, v50
    v_cvt_pk_bf16_f32 v54, v42, v42
    v_lshlrev_b32 v54, 16, v54
    v_add_f32 v50, v50, v54
    v_mul_f32 v51, s68, v51
    v_cvt_pk_bf16_f32 v51, v51, v51
    v_lshlrev_b32 v51, 16, v51
    v_cvt_pk_bf16_f32 v55, v43, v43
    v_lshlrev_b32 v55, 16, v55
    v_add_f32 v51, v51, v55
    v_cvt_pk_bf16_f32 v56, v48, v49
    v_cvt_pk_bf16_f32 v57, v50, v51
    buffer_store_dwordx2 v[56:57], v15, s[28:31], 0 offen offset:32
    v_and_b32 v48, 0xffff0000, v23
    v_lshlrev_b32 v49, 16, v23
    v_and_b32 v50, 0xffff0000, v22
    v_lshlrev_b32 v51, 16, v22
    v_mul_f32 v48, s68, v48
    v_cvt_pk_bf16_f32 v48, v48, v48
    v_lshlrev_b32 v48, 16, v48
    v_cvt_pk_bf16_f32 v52, v44, v44
    v_lshlrev_b32 v52, 16, v52
    v_add_f32 v48, v48, v52
    v_mul_f32 v49, s68, v49
    v_cvt_pk_bf16_f32 v49, v49, v49
    v_lshlrev_b32 v49, 16, v49
    v_cvt_pk_bf16_f32 v53, v45, v45
    v_lshlrev_b32 v53, 16, v53
    v_add_f32 v49, v49, v53
    v_mul_f32 v50, s68, v50
    v_cvt_pk_bf16_f32 v50, v50, v50
    v_lshlrev_b32 v50, 16, v50
    v_cvt_pk_bf16_f32 v54, v46, v46
    v_lshlrev_b32 v54, 16, v54
    v_add_f32 v50, v50, v54
    v_mul_f32 v51, s68, v51
    v_cvt_pk_bf16_f32 v51, v51, v51
    v_lshlrev_b32 v51, 16, v51
    v_cvt_pk_bf16_f32 v55, v47, v47
    v_lshlrev_b32 v55, 16, v55
    v_add_f32 v51, v51, v55
    v_cvt_pk_bf16_f32 v58, v48, v49
    v_cvt_pk_bf16_f32 v59, v50, v51
    buffer_store_dwordx2 v[58:59], v15, s[28:31], 0 offen offset:48
K2_END:
    s_endpgm
.globl k3_kernel
.p2align 8
.type k3_kernel,@function
k3_kernel:
    s_cmp_ge_u32 s2, 256
    s_cbranch_scc1 K3_END
    s_load_dwordx2 s[4:5], s[0:1], 0
    s_load_dwordx2 s[10:11], s[0:1], 80
    s_load_dwordx2 s[12:13], s[0:1], 96
    v_and_b32 v1, 63, v0
    v_lshrrev_b32 v2, 6, v0
    s_nop 1
    v_readfirstlane_b32 s32, v2
    s_lshr_b32 s6, s2, 3
    s_lshl_b32 s6, s6, 6
    s_lshr_b32 s37, s32, 1
    s_lshl_b32 s3, s37, 5
    s_add_u32 s3, s3, s6
    s_and_b32 s33, s2, 7
    s_lshl_b32 s33, s33, 1
    s_and_b32 s34, s32, 1
    s_add_u32 s33, s33, s34
    s_lshl_b32 s36, s33, 5
    s_waitcnt lgkmcnt(0)
    s_mov_b32 s16, s4
    s_and_b32 s17, s5, 0xffff
    s_mov_b32 s18, 2097152
    s_mov_b32 s19, 0x00020000
    s_mov_b32 s24, s10
    s_and_b32 s25, s11, 0xffff
    s_mov_b32 s26, 2097152
    s_mov_b32 s27, 0x00020000
    s_mov_b32 s28, s12
    s_and_b32 s29, s13, 0xffff
    s_mov_b32 s30, 268435456
    s_mov_b32 s31, 0x00020000
    v_and_b32 v8, 31, v1
    v_lshrrev_b32 v9, 5, v1
    s_and_b32 s43, s2, 7
    s_lshl_b32 s43, s43, 16
    s_add_u32 s43, s43, 8388608
    s_lshl_b32 s44, s6, 10
    s_add_u32 s44, s44, 9437184
    v_lshlrev_b32 v11, 4, v0
    v_lshlrev_b32 v12, 4, v1
    v_mul_u32_u24 v17, 1040, v2
    v_add_u32 v12, v12, v17
    s_add_u32 s45, s43, 0
    buffer_load_dwordx4 v[64:67], v11, s[28:31], s45 offen
    s_add_u32 s45, s43, 4096
    buffer_load_dwordx4 v[68:71], v11, s[28:31], s45 offen
    s_add_u32 s45, s43, 8192
    buffer_load_dwordx4 v[72:75], v11, s[28:31], s45 offen
    s_add_u32 s45, s43, 12288
    buffer_load_dwordx4 v[76:79], v11, s[28:31], s45 offen
    s_add_u32 s45, s43, 16384
    buffer_load_dwordx4 v[80:83], v11, s[28:31], s45 offen
    s_add_u32 s45, s43, 20480
    buffer_load_dwordx4 v[84:87], v11, s[28:31], s45 offen
    s_add_u32 s45, s43, 24576
    buffer_load_dwordx4 v[88:91], v11, s[28:31], s45 offen
    s_add_u32 s45, s43, 28672
    buffer_load_dwordx4 v[92:95], v11, s[28:31], s45 offen
    s_add_u32 s45, s43, 32768
    buffer_load_dwordx4 v[96:99], v11, s[28:31], s45 offen
    s_add_u32 s45, s43, 36864
    buffer_load_dwordx4 v[100:103], v11, s[28:31], s45 offen
    s_add_u32 s45, s43, 40960
    buffer_load_dwordx4 v[104:107], v11, s[28:31], s45 offen
    s_add_u32 s45, s43, 45056
    buffer_load_dwordx4 v[108:111], v11, s[28:31], s45 offen
    s_add_u32 s45, s43, 49152
    buffer_load_dwordx4 v[112:115], v11, s[28:31], s45 offen
    s_add_u32 s45, s43, 53248
    buffer_load_dwordx4 v[116:119], v11, s[28:31], s45 offen
    s_add_u32 s45, s43, 57344
    buffer_load_dwordx4 v[120:123], v11, s[28:31], s45 offen
    s_add_u32 s45, s43, 61440
    buffer_load_dwordx4 v[124:127], v11, s[28:31], s45 offen
    s_add_u32 s45, s44, 0
    buffer_load_dwordx4 v[128:131], v11, s[28:31], s45 offen
    s_add_u32 s45, s44, 4096
    buffer_load_dwordx4 v[132:135], v11, s[28:31], s45 offen
    s_add_u32 s45, s44, 8192
    buffer_load_dwordx4 v[136:139], v11, s[28:31], s45 offen
    s_add_u32 s45, s44, 12288
    buffer_load_dwordx4 v[140:143], v11, s[28:31], s45 offen
    s_add_u32 s45, s44, 16384
    buffer_load_dwordx4 v[144:147], v11, s[28:31], s45 offen
    s_add_u32 s45, s44, 20480
    buffer_load_dwordx4 v[148:151], v11, s[28:31], s45 offen
    s_add_u32 s45, s44, 24576
    buffer_load_dwordx4 v[152:155], v11, s[28:31], s45 offen
    s_add_u32 s45, s44, 28672
    buffer_load_dwordx4 v[156:159], v11, s[28:31], s45 offen
    s_add_u32 s45, s44, 32768
    buffer_load_dwordx4 v[160:163], v11, s[28:31], s45 offen
    s_add_u32 s45, s44, 36864
    buffer_load_dwordx4 v[164:167], v11, s[28:31], s45 offen
    s_add_u32 s45, s44, 40960
    buffer_load_dwordx4 v[168:171], v11, s[28:31], s45 offen
    s_add_u32 s45, s44, 45056
    buffer_load_dwordx4 v[172:175], v11, s[28:31], s45 offen
    s_add_u32 s45, s44, 49152
    buffer_load_dwordx4 v[176:179], v11, s[28:31], s45 offen
    s_add_u32 s45, s44, 53248
    buffer_load_dwordx4 v[180:183], v11, s[28:31], s45 offen
    s_add_u32 s45, s44, 57344
    buffer_load_dwordx4 v[184:187], v11, s[28:31], s45 offen
    s_add_u32 s45, s44, 61440
    buffer_load_dwordx4 v[188:191], v11, s[28:31], s45 offen
    v_add_u32 v13, s3, v8
    v_lshlrev_b32 v14, 2, v13
    v_add_u32 v14, 11534336, v14
    v_lshlrev_b32 v13, 10, v13
    v_lshl_add_u32 v13, v9, 3, v13
    s_lshl_b32 s38, s36, 1
    v_add_u32 v13, s38, v13
    v_lshl_add_u32 v15, v9, 2, s36
    v_lshlrev_b32 v15, 12, v15
    v_add_u32 v3, s3, v8
    v_lshl_add_u32 v15, v3, 1, v15
    v_add_u32 v15, 6291456, v15
    buffer_load_dword v4, v14, s[28:31], 0 offen
    buffer_load_dwordx2 v[192:193], v13, s[16:19], 0 offen offset:0
    s_mov_b32 s41, 0
    buffer_load_ushort v200, v15, s[28:31], s41 offen
    s_mov_b32 s41, 4096
    buffer_load_ushort v201, v15, s[28:31], s41 offen
    s_mov_b32 s41, 8192
    buffer_load_ushort v202, v15, s[28:31], s41 offen
    s_mov_b32 s41, 12288
    buffer_load_ushort v203, v15, s[28:31], s41 offen
    buffer_load_dwordx2 v[194:195], v13, s[16:19], 0 offen offset:16
    s_mov_b32 s41, 32768
    buffer_load_ushort v204, v15, s[28:31], s41 offen
    s_mov_b32 s41, 36864
    buffer_load_ushort v205, v15, s[28:31], s41 offen
    s_mov_b32 s41, 40960
    buffer_load_ushort v206, v15, s[28:31], s41 offen
    s_mov_b32 s41, 45056
    buffer_load_ushort v207, v15, s[28:31], s41 offen
    buffer_load_dwordx2 v[196:197], v13, s[16:19], 0 offen offset:32
    s_mov_b32 s41, 65536
    buffer_load_ushort v208, v15, s[28:31], s41 offen
    s_mov_b32 s41, 69632
    buffer_load_ushort v209, v15, s[28:31], s41 offen
    s_mov_b32 s41, 73728
    buffer_load_ushort v210, v15, s[28:31], s41 offen
    s_mov_b32 s41, 77824
    buffer_load_ushort v211, v15, s[28:31], s41 offen
    buffer_load_dwordx2 v[198:199], v13, s[16:19], 0 offen offset:48
    s_mov_b32 s41, 98304
    buffer_load_ushort v212, v15, s[28:31], s41 offen
    s_mov_b32 s41, 102400
    buffer_load_ushort v213, v15, s[28:31], s41 offen
    s_mov_b32 s41, 106496
    buffer_load_ushort v214, v15, s[28:31], s41 offen
    s_mov_b32 s41, 110592
    buffer_load_ushort v215, v15, s[28:31], s41 offen
    s_waitcnt vmcnt(52)
    ds_write_b128 v12, v[64:67] offset:0
    s_waitcnt vmcnt(51)
    ds_write_b128 v12, v[68:71] offset:4160
    s_waitcnt vmcnt(50)
    ds_write_b128 v12, v[72:75] offset:8320
    s_waitcnt vmcnt(49)
    ds_write_b128 v12, v[76:79] offset:12480
    s_waitcnt vmcnt(48)
    ds_write_b128 v12, v[80:83] offset:16640
    s_waitcnt vmcnt(47)
    ds_write_b128 v12, v[84:87] offset:20800
    s_waitcnt vmcnt(46)
    ds_write_b128 v12, v[88:91] offset:24960
    s_waitcnt vmcnt(45)
    ds_write_b128 v12, v[92:95] offset:29120
    s_waitcnt vmcnt(44)
    ds_write_b128 v12, v[96:99] offset:33280
    s_waitcnt vmcnt(43)
    ds_write_b128 v12, v[100:103] offset:37440
    s_waitcnt vmcnt(42)
    ds_write_b128 v12, v[104:107] offset:41600
    s_waitcnt vmcnt(41)
    ds_write_b128 v12, v[108:111] offset:45760
    s_waitcnt vmcnt(40)
    v_add_u32 v12, 49920, v12
    ds_write_b128 v12, v[112:115] offset:0
    s_waitcnt vmcnt(39)
    ds_write_b128 v12, v[116:119] offset:4160
    s_waitcnt vmcnt(38)
    ds_write_b128 v12, v[120:123] offset:8320
    s_waitcnt vmcnt(37)
    ds_write_b128 v12, v[124:127] offset:12480
    s_waitcnt vmcnt(36)
    ds_write_b128 v12, v[128:131] offset:16640
    s_waitcnt vmcnt(35)
    ds_write_b128 v12, v[132:135] offset:20800
    s_waitcnt vmcnt(34)
    ds_write_b128 v12, v[136:139] offset:24960
    s_waitcnt vmcnt(33)
    ds_write_b128 v12, v[140:143] offset:29120
    s_waitcnt vmcnt(32)
    ds_write_b128 v12, v[144:147] offset:33280
    s_waitcnt vmcnt(31)
    ds_write_b128 v12, v[148:151] offset:37440
    s_waitcnt vmcnt(30)
    ds_write_b128 v12, v[152:155] offset:41600
    s_waitcnt vmcnt(29)
    ds_write_b128 v12, v[156:159] offset:45760
    s_waitcnt vmcnt(28)
    v_add_u32 v12, 49920, v12
    ds_write_b128 v12, v[160:163] offset:0
    s_waitcnt vmcnt(27)
    ds_write_b128 v12, v[164:167] offset:4160
    s_waitcnt vmcnt(26)
    ds_write_b128 v12, v[168:171] offset:8320
    s_waitcnt vmcnt(25)
    ds_write_b128 v12, v[172:175] offset:12480
    s_waitcnt vmcnt(24)
    ds_write_b128 v12, v[176:179] offset:16640
    s_waitcnt vmcnt(23)
    ds_write_b128 v12, v[180:183] offset:20800
    s_waitcnt vmcnt(22)
    ds_write_b128 v12, v[184:187] offset:24960
    s_waitcnt vmcnt(21)
    ds_write_b128 v12, v[188:191] offset:29120
    s_lshl_b32 s45, s34, 5
    v_add_u32 v11, s45, v8
    v_mul_u32_u24 v11, 1040, v11
    v_lshl_add_u32 v11, v9, 4, v11
    s_lshl_b32 s45, s37, 5
    s_add_u32 s45, s45, 64
    v_add_u32 v12, s45, v8
    v_mul_u32_u24 v12, 1040, v12
    v_lshl_add_u32 v12, v9, 4, v12
    v_mov_b32 v32, 0
    v_mov_b32 v33, 0
    v_mov_b32 v34, 0
    v_mov_b32 v35, 0
    v_mov_b32 v36, 0
    v_mov_b32 v37, 0
    v_mov_b32 v38, 0
    v_mov_b32 v39, 0
    v_mov_b32 v40, 0
    v_mov_b32 v41, 0
    v_mov_b32 v42, 0
    v_mov_b32 v43, 0
    v_mov_b32 v44, 0
    v_mov_b32 v45, 0
    v_mov_b32 v46, 0
    v_mov_b32 v47, 0
    s_waitcnt lgkmcnt(0)
    s_barrier
    ds_read_b128 v[64:67], v11 offset:0
    ds_read_b128 v[68:71], v12 offset:0
    ds_read_b128 v[72:75], v11 offset:32
    ds_read_b128 v[76:79], v12 offset:32
    ds_read_b128 v[80:83], v11 offset:64
    ds_read_b128 v[84:87], v12 offset:64
    ds_read_b128 v[88:91], v11 offset:96
    ds_read_b128 v[92:95], v12 offset:96
    ds_read_b128 v[96:99], v11 offset:128
    ds_read_b128 v[100:103], v12 offset:128
    ds_read_b128 v[104:107], v11 offset:160
    ds_read_b128 v[108:111], v12 offset:160
    ds_read_b128 v[112:115], v11 offset:192
    ds_read_b128 v[116:119], v12 offset:192
    ds_read_b128 v[120:123], v11 offset:224
    ds_read_b128 v[124:127], v12 offset:224
    ds_read_b128 v[128:131], v11 offset:256
    ds_read_b128 v[132:135], v12 offset:256
    ds_read_b128 v[136:139], v11 offset:288
    ds_read_b128 v[140:143], v12 offset:288
    ds_read_b128 v[144:147], v11 offset:320
    ds_read_b128 v[148:151], v12 offset:320
    ds_read_b128 v[152:155], v11 offset:352
    ds_read_b128 v[156:159], v12 offset:352
    ds_read_b128 v[160:163], v11 offset:384
    ds_read_b128 v[164:167], v12 offset:384
    ds_read_b128 v[168:171], v11 offset:416
    ds_read_b128 v[172:175], v12 offset:416
    ds_read_b128 v[176:179], v11 offset:448
    ds_read_b128 v[180:183], v12 offset:448
    ds_read_b128 v[184:187], v11 offset:480
    ds_read_b128 v[188:191], v12 offset:480
    s_waitcnt lgkmcnt(15)
    v_mfma_f32_32x32x16_bf16 v[32:47], v[64:67], v[68:71], v[32:47]
    s_waitcnt lgkmcnt(15)
    v_mfma_f32_32x32x16_bf16 v[32:47], v[72:75], v[76:79], v[32:47]
    s_waitcnt lgkmcnt(15)
    v_mfma_f32_32x32x16_bf16 v[32:47], v[80:83], v[84:87], v[32:47]
    s_waitcnt lgkmcnt(15)
    v_mfma_f32_32x32x16_bf16 v[32:47], v[88:91], v[92:95], v[32:47]
    s_waitcnt lgkmcnt(15)
    v_mfma_f32_32x32x16_bf16 v[32:47], v[96:99], v[100:103], v[32:47]
    s_waitcnt lgkmcnt(15)
    v_mfma_f32_32x32x16_bf16 v[32:47], v[104:107], v[108:111], v[32:47]
    s_waitcnt lgkmcnt(15)
    v_mfma_f32_32x32x16_bf16 v[32:47], v[112:115], v[116:119], v[32:47]
    s_waitcnt lgkmcnt(15)
    v_mfma_f32_32x32x16_bf16 v[32:47], v[120:123], v[124:127], v[32:47]
    s_waitcnt lgkmcnt(14)
    v_mfma_f32_32x32x16_bf16 v[32:47], v[128:131], v[132:135], v[32:47]
    s_waitcnt lgkmcnt(12)
    v_mfma_f32_32x32x16_bf16 v[32:47], v[136:139], v[140:143], v[32:47]
    s_waitcnt lgkmcnt(10)
    v_mfma_f32_32x32x16_bf16 v[32:47], v[144:147], v[148:151], v[32:47]
    s_waitcnt lgkmcnt(8)
    v_mfma_f32_32x32x16_bf16 v[32:47], v[152:155], v[156:159], v[32:47]
    s_waitcnt lgkmcnt(6)
    v_mfma_f32_32x32x16_bf16 v[32:47], v[160:163], v[164:167], v[32:47]
    s_waitcnt lgkmcnt(4)
    v_mfma_f32_32x32x16_bf16 v[32:47], v[168:171], v[172:175], v[32:47]
    s_waitcnt lgkmcnt(2)
    v_mfma_f32_32x32x16_bf16 v[32:47], v[176:179], v[180:183], v[32:47]
    s_waitcnt lgkmcnt(0)
    v_mfma_f32_32x32x16_bf16 v[32:47], v[184:187], v[188:191], v[32:47]
    ds_read_b128 v[64:67], v11 offset:512
    ds_read_b128 v[68:71], v12 offset:512
    ds_read_b128 v[72:75], v11 offset:544
    ds_read_b128 v[76:79], v12 offset:544
    ds_read_b128 v[80:83], v11 offset:576
    ds_read_b128 v[84:87], v12 offset:576
    ds_read_b128 v[88:91], v11 offset:608
    ds_read_b128 v[92:95], v12 offset:608
    ds_read_b128 v[96:99], v11 offset:640
    ds_read_b128 v[100:103], v12 offset:640
    ds_read_b128 v[104:107], v11 offset:672
    ds_read_b128 v[108:111], v12 offset:672
    ds_read_b128 v[112:115], v11 offset:704
    ds_read_b128 v[116:119], v12 offset:704
    ds_read_b128 v[120:123], v11 offset:736
    ds_read_b128 v[124:127], v12 offset:736
    ds_read_b128 v[128:131], v11 offset:768
    ds_read_b128 v[132:135], v12 offset:768
    ds_read_b128 v[136:139], v11 offset:800
    ds_read_b128 v[140:143], v12 offset:800
    ds_read_b128 v[144:147], v11 offset:832
    ds_read_b128 v[148:151], v12 offset:832
    ds_read_b128 v[152:155], v11 offset:864
    ds_read_b128 v[156:159], v12 offset:864
    ds_read_b128 v[160:163], v11 offset:896
    ds_read_b128 v[164:167], v12 offset:896
    ds_read_b128 v[168:171], v11 offset:928
    ds_read_b128 v[172:175], v12 offset:928
    ds_read_b128 v[176:179], v11 offset:960
    ds_read_b128 v[180:183], v12 offset:960
    ds_read_b128 v[184:187], v11 offset:992
    ds_read_b128 v[188:191], v12 offset:992
    s_waitcnt lgkmcnt(15)
    v_mfma_f32_32x32x16_bf16 v[32:47], v[64:67], v[68:71], v[32:47]
    s_waitcnt lgkmcnt(15)
    v_mfma_f32_32x32x16_bf16 v[32:47], v[72:75], v[76:79], v[32:47]
    s_waitcnt lgkmcnt(15)
    v_mfma_f32_32x32x16_bf16 v[32:47], v[80:83], v[84:87], v[32:47]
    s_waitcnt lgkmcnt(15)
    v_mfma_f32_32x32x16_bf16 v[32:47], v[88:91], v[92:95], v[32:47]
    s_waitcnt lgkmcnt(15)
    v_mfma_f32_32x32x16_bf16 v[32:47], v[96:99], v[100:103], v[32:47]
    s_waitcnt lgkmcnt(15)
    v_mfma_f32_32x32x16_bf16 v[32:47], v[104:107], v[108:111], v[32:47]
    s_waitcnt lgkmcnt(15)
    v_mfma_f32_32x32x16_bf16 v[32:47], v[112:115], v[116:119], v[32:47]
    s_waitcnt lgkmcnt(15)
    v_mfma_f32_32x32x16_bf16 v[32:47], v[120:123], v[124:127], v[32:47]
    s_waitcnt lgkmcnt(14)
    v_mfma_f32_32x32x16_bf16 v[32:47], v[128:131], v[132:135], v[32:47]
    s_waitcnt lgkmcnt(12)
    v_mfma_f32_32x32x16_bf16 v[32:47], v[136:139], v[140:143], v[32:47]
    s_waitcnt lgkmcnt(10)
    v_mfma_f32_32x32x16_bf16 v[32:47], v[144:147], v[148:151], v[32:47]
    s_waitcnt lgkmcnt(8)
    v_mfma_f32_32x32x16_bf16 v[32:47], v[152:155], v[156:159], v[32:47]
    s_waitcnt lgkmcnt(6)
    v_mfma_f32_32x32x16_bf16 v[32:47], v[160:163], v[164:167], v[32:47]
    s_waitcnt lgkmcnt(4)
    v_mfma_f32_32x32x16_bf16 v[32:47], v[168:171], v[172:175], v[32:47]
    s_waitcnt lgkmcnt(2)
    v_mfma_f32_32x32x16_bf16 v[32:47], v[176:179], v[180:183], v[32:47]
    s_waitcnt lgkmcnt(0)
    v_mfma_f32_32x32x16_bf16 v[32:47], v[184:187], v[188:191], v[32:47]
    s_nop 7
    s_nop 7
    s_waitcnt vmcnt(0)
    v_sub_f32 v5, 1.0, v4
    v_cvt_pk_bf16_f32 v5, v5, v5
    v_lshlrev_b32 v5, 16, v5
    v_lshlrev_b32 v24, 16, v192
    v_and_b32 v25, 0xffff0000, v192
    v_lshlrev_b32 v26, 16, v193
    v_and_b32 v27, 0xffff0000, v193
    v_lshlrev_b32 v20, 16, v200
    v_mul_f32 v20, v20, v24
    v_cvt_pk_bf16_f32 v20, v20, v20
    v_lshlrev_b32 v20, 16, v20
    v_mul_f32 v20, v4, v20
    v_cvt_pk_bf16_f32 v20, v20, v20
    v_lshlrev_b32 v20, 16, v20
    v_cvt_pk_bf16_f32 v24, v32, v32
    v_lshlrev_b32 v24, 16, v24
    v_mul_f32 v24, v5, v24
    v_cvt_pk_bf16_f32 v24, v24, v24
    v_lshlrev_b32 v24, 16, v24
    v_add_f32 v20, v20, v24
    v_lshlrev_b32 v21, 16, v201
    v_mul_f32 v21, v21, v25
    v_cvt_pk_bf16_f32 v21, v21, v21
    v_lshlrev_b32 v21, 16, v21
    v_mul_f32 v21, v4, v21
    v_cvt_pk_bf16_f32 v21, v21, v21
    v_lshlrev_b32 v21, 16, v21
    v_cvt_pk_bf16_f32 v25, v33, v33
    v_lshlrev_b32 v25, 16, v25
    v_mul_f32 v25, v5, v25
    v_cvt_pk_bf16_f32 v25, v25, v25
    v_lshlrev_b32 v25, 16, v25
    v_add_f32 v21, v21, v25
    v_lshlrev_b32 v22, 16, v202
    v_mul_f32 v22, v22, v26
    v_cvt_pk_bf16_f32 v22, v22, v22
    v_lshlrev_b32 v22, 16, v22
    v_mul_f32 v22, v4, v22
    v_cvt_pk_bf16_f32 v22, v22, v22
    v_lshlrev_b32 v22, 16, v22
    v_cvt_pk_bf16_f32 v26, v34, v34
    v_lshlrev_b32 v26, 16, v26
    v_mul_f32 v26, v5, v26
    v_cvt_pk_bf16_f32 v26, v26, v26
    v_lshlrev_b32 v26, 16, v26
    v_add_f32 v22, v22, v26
    v_lshlrev_b32 v23, 16, v203
    v_mul_f32 v23, v23, v27
    v_cvt_pk_bf16_f32 v23, v23, v23
    v_lshlrev_b32 v23, 16, v23
    v_mul_f32 v23, v4, v23
    v_cvt_pk_bf16_f32 v23, v23, v23
    v_lshlrev_b32 v23, 16, v23
    v_cvt_pk_bf16_f32 v27, v35, v35
    v_lshlrev_b32 v27, 16, v27
    v_mul_f32 v27, v5, v27
    v_cvt_pk_bf16_f32 v27, v27, v27
    v_lshlrev_b32 v27, 16, v27
    v_add_f32 v23, v23, v27
    v_cvt_pk_bf16_f32 v28, v20, v21
    v_cvt_pk_bf16_f32 v29, v22, v23
    buffer_store_dwordx2 v[28:29], v13, s[24:27], 0 offen offset:0
    v_lshlrev_b32 v24, 16, v194
    v_and_b32 v25, 0xffff0000, v194
    v_lshlrev_b32 v26, 16, v195
    v_and_b32 v27, 0xffff0000, v195
    v_lshlrev_b32 v20, 16, v204
    v_mul_f32 v20, v20, v24
    v_cvt_pk_bf16_f32 v20, v20, v20
    v_lshlrev_b32 v20, 16, v20
    v_mul_f32 v20, v4, v20
    v_cvt_pk_bf16_f32 v20, v20, v20
    v_lshlrev_b32 v20, 16, v20
    v_cvt_pk_bf16_f32 v24, v36, v36
    v_lshlrev_b32 v24, 16, v24
    v_mul_f32 v24, v5, v24
    v_cvt_pk_bf16_f32 v24, v24, v24
    v_lshlrev_b32 v24, 16, v24
    v_add_f32 v20, v20, v24
    v_lshlrev_b32 v21, 16, v205
    v_mul_f32 v21, v21, v25
    v_cvt_pk_bf16_f32 v21, v21, v21
    v_lshlrev_b32 v21, 16, v21
    v_mul_f32 v21, v4, v21
    v_cvt_pk_bf16_f32 v21, v21, v21
    v_lshlrev_b32 v21, 16, v21
    v_cvt_pk_bf16_f32 v25, v37, v37
    v_lshlrev_b32 v25, 16, v25
    v_mul_f32 v25, v5, v25
    v_cvt_pk_bf16_f32 v25, v25, v25
    v_lshlrev_b32 v25, 16, v25
    v_add_f32 v21, v21, v25
    v_lshlrev_b32 v22, 16, v206
    v_mul_f32 v22, v22, v26
    v_cvt_pk_bf16_f32 v22, v22, v22
    v_lshlrev_b32 v22, 16, v22
    v_mul_f32 v22, v4, v22
    v_cvt_pk_bf16_f32 v22, v22, v22
    v_lshlrev_b32 v22, 16, v22
    v_cvt_pk_bf16_f32 v26, v38, v38
    v_lshlrev_b32 v26, 16, v26
    v_mul_f32 v26, v5, v26
    v_cvt_pk_bf16_f32 v26, v26, v26
    v_lshlrev_b32 v26, 16, v26
    v_add_f32 v22, v22, v26
    v_lshlrev_b32 v23, 16, v207
    v_mul_f32 v23, v23, v27
    v_cvt_pk_bf16_f32 v23, v23, v23
    v_lshlrev_b32 v23, 16, v23
    v_mul_f32 v23, v4, v23
    v_cvt_pk_bf16_f32 v23, v23, v23
    v_lshlrev_b32 v23, 16, v23
    v_cvt_pk_bf16_f32 v27, v39, v39
    v_lshlrev_b32 v27, 16, v27
    v_mul_f32 v27, v5, v27
    v_cvt_pk_bf16_f32 v27, v27, v27
    v_lshlrev_b32 v27, 16, v27
    v_add_f32 v23, v23, v27
    v_cvt_pk_bf16_f32 v30, v20, v21
    v_cvt_pk_bf16_f32 v31, v22, v23
    buffer_store_dwordx2 v[30:31], v13, s[24:27], 0 offen offset:16
    v_lshlrev_b32 v24, 16, v196
    v_and_b32 v25, 0xffff0000, v196
    v_lshlrev_b32 v26, 16, v197
    v_and_b32 v27, 0xffff0000, v197
    v_lshlrev_b32 v20, 16, v208
    v_mul_f32 v20, v20, v24
    v_cvt_pk_bf16_f32 v20, v20, v20
    v_lshlrev_b32 v20, 16, v20
    v_mul_f32 v20, v4, v20
    v_cvt_pk_bf16_f32 v20, v20, v20
    v_lshlrev_b32 v20, 16, v20
    v_cvt_pk_bf16_f32 v24, v40, v40
    v_lshlrev_b32 v24, 16, v24
    v_mul_f32 v24, v5, v24
    v_cvt_pk_bf16_f32 v24, v24, v24
    v_lshlrev_b32 v24, 16, v24
    v_add_f32 v20, v20, v24
    v_lshlrev_b32 v21, 16, v209
    v_mul_f32 v21, v21, v25
    v_cvt_pk_bf16_f32 v21, v21, v21
    v_lshlrev_b32 v21, 16, v21
    v_mul_f32 v21, v4, v21
    v_cvt_pk_bf16_f32 v21, v21, v21
    v_lshlrev_b32 v21, 16, v21
    v_cvt_pk_bf16_f32 v25, v41, v41
    v_lshlrev_b32 v25, 16, v25
    v_mul_f32 v25, v5, v25
    v_cvt_pk_bf16_f32 v25, v25, v25
    v_lshlrev_b32 v25, 16, v25
    v_add_f32 v21, v21, v25
    v_lshlrev_b32 v22, 16, v210
    v_mul_f32 v22, v22, v26
    v_cvt_pk_bf16_f32 v22, v22, v22
    v_lshlrev_b32 v22, 16, v22
    v_mul_f32 v22, v4, v22
    v_cvt_pk_bf16_f32 v22, v22, v22
    v_lshlrev_b32 v22, 16, v22
    v_cvt_pk_bf16_f32 v26, v42, v42
    v_lshlrev_b32 v26, 16, v26
    v_mul_f32 v26, v5, v26
    v_cvt_pk_bf16_f32 v26, v26, v26
    v_lshlrev_b32 v26, 16, v26
    v_add_f32 v22, v22, v26
    v_lshlrev_b32 v23, 16, v211
    v_mul_f32 v23, v23, v27
    v_cvt_pk_bf16_f32 v23, v23, v23
    v_lshlrev_b32 v23, 16, v23
    v_mul_f32 v23, v4, v23
    v_cvt_pk_bf16_f32 v23, v23, v23
    v_lshlrev_b32 v23, 16, v23
    v_cvt_pk_bf16_f32 v27, v43, v43
    v_lshlrev_b32 v27, 16, v27
    v_mul_f32 v27, v5, v27
    v_cvt_pk_bf16_f32 v27, v27, v27
    v_lshlrev_b32 v27, 16, v27
    v_add_f32 v23, v23, v27
    v_cvt_pk_bf16_f32 v28, v20, v21
    v_cvt_pk_bf16_f32 v29, v22, v23
    buffer_store_dwordx2 v[28:29], v13, s[24:27], 0 offen offset:32
    v_lshlrev_b32 v24, 16, v198
    v_and_b32 v25, 0xffff0000, v198
    v_lshlrev_b32 v26, 16, v199
    v_and_b32 v27, 0xffff0000, v199
    v_lshlrev_b32 v20, 16, v212
    v_mul_f32 v20, v20, v24
    v_cvt_pk_bf16_f32 v20, v20, v20
    v_lshlrev_b32 v20, 16, v20
    v_mul_f32 v20, v4, v20
    v_cvt_pk_bf16_f32 v20, v20, v20
    v_lshlrev_b32 v20, 16, v20
    v_cvt_pk_bf16_f32 v24, v44, v44
    v_lshlrev_b32 v24, 16, v24
    v_mul_f32 v24, v5, v24
    v_cvt_pk_bf16_f32 v24, v24, v24
    v_lshlrev_b32 v24, 16, v24
    v_add_f32 v20, v20, v24
    v_lshlrev_b32 v21, 16, v213
    v_mul_f32 v21, v21, v25
    v_cvt_pk_bf16_f32 v21, v21, v21
    v_lshlrev_b32 v21, 16, v21
    v_mul_f32 v21, v4, v21
    v_cvt_pk_bf16_f32 v21, v21, v21
    v_lshlrev_b32 v21, 16, v21
    v_cvt_pk_bf16_f32 v25, v45, v45
    v_lshlrev_b32 v25, 16, v25
    v_mul_f32 v25, v5, v25
    v_cvt_pk_bf16_f32 v25, v25, v25
    v_lshlrev_b32 v25, 16, v25
    v_add_f32 v21, v21, v25
    v_lshlrev_b32 v22, 16, v214
    v_mul_f32 v22, v22, v26
    v_cvt_pk_bf16_f32 v22, v22, v22
    v_lshlrev_b32 v22, 16, v22
    v_mul_f32 v22, v4, v22
    v_cvt_pk_bf16_f32 v22, v22, v22
    v_lshlrev_b32 v22, 16, v22
    v_cvt_pk_bf16_f32 v26, v46, v46
    v_lshlrev_b32 v26, 16, v26
    v_mul_f32 v26, v5, v26
    v_cvt_pk_bf16_f32 v26, v26, v26
    v_lshlrev_b32 v26, 16, v26
    v_add_f32 v22, v22, v26
    v_lshlrev_b32 v23, 16, v215
    v_mul_f32 v23, v23, v27
    v_cvt_pk_bf16_f32 v23, v23, v23
    v_lshlrev_b32 v23, 16, v23
    v_mul_f32 v23, v4, v23
    v_cvt_pk_bf16_f32 v23, v23, v23
    v_lshlrev_b32 v23, 16, v23
    v_cvt_pk_bf16_f32 v27, v47, v47
    v_lshlrev_b32 v27, 16, v27
    v_mul_f32 v27, v5, v27
    v_cvt_pk_bf16_f32 v27, v27, v27
    v_lshlrev_b32 v27, 16, v27
    v_add_f32 v23, v23, v27
    v_cvt_pk_bf16_f32 v30, v20, v21
    v_cvt_pk_bf16_f32 v31, v22, v23
    buffer_store_dwordx2 v[30:31], v13, s[24:27], 0 offen offset:48
K3_END:
    s_endpgm
.section .rodata,"a"
.p2align 6
.amdhsa_kernel k1_kernel
  .amdhsa_next_free_vgpr 168
  .amdhsa_next_free_sgpr 102
  .amdhsa_accum_offset 168
  .amdhsa_group_segment_fixed_size 0
  .amdhsa_kernarg_size 104
  .amdhsa_user_sgpr_count 2
  .amdhsa_user_sgpr_kernarg_segment_ptr 1
  .amdhsa_system_sgpr_workgroup_id_x 1
.end_amdhsa_kernel
.p2align 6
.amdhsa_kernel k2_kernel
  .amdhsa_next_free_vgpr 168
  .amdhsa_next_free_sgpr 102
  .amdhsa_accum_offset 168
  .amdhsa_group_segment_fixed_size 0
  .amdhsa_kernarg_size 104
  .amdhsa_user_sgpr_count 2
  .amdhsa_user_sgpr_kernarg_segment_ptr 1
  .amdhsa_system_sgpr_workgroup_id_x 1
.end_amdhsa_kernel
.p2align 6
.amdhsa_kernel k3_kernel
  .amdhsa_next_free_vgpr 256
  .amdhsa_next_free_sgpr 102
  .amdhsa_accum_offset 256
  .amdhsa_group_segment_fixed_size 0
  .amdhsa_kernarg_size 104
  .amdhsa_user_sgpr_count 2
  .amdhsa_user_sgpr_kernarg_segment_ptr 1
  .amdhsa_system_sgpr_workgroup_id_x 1
.end_amdhsa_kernel
```
